```python
import torch

def _softmax(x, axis=-1):
    return torch.softmax(x, dim=axis)
def _gelu(x):
    return torch.nn.functional.gelu(x, approximate="tanh")
def _silu(x):
    return torch.nn.functional.silu(x)
def _sigmoid(x):
    return torch.sigmoid(x)
def _layernorm(x, axis=-1, eps=1e-5):
    m = x.mean(dim=axis, keepdim=True)
    v = x.var(dim=axis, keepdim=True, unbiased=False)
    return (x - m) / torch.sqrt(v + eps)
def _scatter_add(tgt, idx, src, axis=0):
    return tgt.clone().index_add_(axis, idx, src)
def _segment_sum(src, seg, n):
    out = torch.zeros((n,) + src.shape[1:], dtype=src.dtype)
    return out.index_add_(0, seg, src)
def _pad(x, pw):
    flat = tuple(v for pair in reversed(pw) for v in pair)
    return torch.nn.functional.pad(x, flat)

kernel_name = 'gated_mix__linear_kernel_hedgehog__softmax_full_mha__prompt'

def setup_inputs():

    _w = (lambda a: (lambda t: t.to(torch.bfloat16) if t.is_floating_point() else t)(torch.as_tensor(a)))
    def _A_setup():
        B, S, D, H = 1, 2048, 448, 16
        Dh = D // H
        return {
            "x": _w((lambda *s: torch.randn(*s, dtype=torch.bfloat16) * 0.05)(B, S, D)),
            "wqkv": _w((lambda *s: torch.randn(*s, dtype=torch.bfloat16) * 3.2)(D, 3 * D)),
            "w_phi": _w((lambda *s: torch.randn(*s, dtype=torch.bfloat16) * 3.2)(H, Dh, Dh) * (Dh ** -0.5)),
            "wo": _w((lambda *s: torch.randn(*s, dtype=torch.bfloat16) * 0.05)(D, D)),
        }
    _A_in = _A_setup()

    def _B_setup():
        B, S, D = 1, 2048, 448
        return {
            "x": _w((lambda *s: torch.randn(*s, dtype=torch.bfloat16) * 0.05)(B, S, D)),
            "wqkv": _w((lambda *s: torch.randn(*s, dtype=torch.bfloat16) * 1.6)(D, 3 * D)),
            "wo": _w((lambda *s: torch.randn(*s, dtype=torch.bfloat16) * 0.05)(D, D)),
        }
    _B_in = _B_setup()

    return {
        "A_x": _A_in["x"],
        "A_wqkv": _A_in["wqkv"],
        "A_w_phi": _A_in["w_phi"],
        "A_wo": _A_in["wo"],
        "B_x": _B_in["x"],
        "B_wqkv": _B_in["wqkv"],
        "B_wo": _B_in["wo"],
        "gate_w": _w((lambda *s: torch.randn(*s, dtype=torch.bfloat16) * 0.05)(448) * 16.0),
    }

def reference(A_x, A_wqkv, A_w_phi, A_wo, B_x, B_wqkv, B_wo, gate_w):
    def _A_ref(x, wqkv, w_phi, wo):
        B, S, D = x.shape
        H = 16; Dh = D // H
        qkv = (lambda x, *d: x.permute(*d))((x @ wqkv).reshape(B, S, 3, H, Dh), 2, 0, 3, 1, 4)
        q, k, v = qkv[0], qkv[1], qkv[2]
        pq = torch.einsum("bhsd,hdf->bhsf", q, w_phi)
        pk = torch.einsum("bhsd,hdf->bhsf", k, w_phi)
        phi_q = torch.concatenate([_softmax(pq, axis=-1), _softmax(-pq, axis=-1)], axis=-1)
        phi_k = torch.concatenate([_softmax(pk, axis=-1), _softmax(-pk, axis=-1)], axis=-1)
        kv = torch.einsum("bhsf,bhsd->bhfd", phi_k, v)
        z  = torch.einsum("bhsf->bhf", phi_k)
        num = torch.einsum("bhqf,bhfd->bhqd", phi_q, kv)
        den = torch.einsum("bhqf,bhf->bhq", phi_q, z)[..., None] + 1e-6
        o = num / den
        return (lambda x, *d: x.permute(*d))(o, 0, 2, 1, 3).reshape(B, S, D) @ wo

    def _B_ref(x, wqkv, wo):
        B, S, D = x.shape
        H = 16; Dh = D // H
        qkv = (lambda x, *d: x.permute(*d))((x @ wqkv).reshape(B, S, 3, H, Dh), 2, 0, 3, 1, 4)
        q, k, v = qkv[0], qkv[1], qkv[2]
        scale = Dh ** -0.5
        scores = torch.einsum("bhqd,bhkd->bhqk", q, k) * scale
        p = _softmax(scores, axis=-1)
        o = torch.einsum("bhqk,bhkd->bhqd", p, v)
        return (lambda x, *d: x.permute(*d))(o, 0, 2, 1, 3).reshape(B, S, D) @ wo

    x = A_x
    g = _sigmoid((x * gate_w).sum(-1, keepdims=True))
    a = _A_ref(x, A_wqkv, A_w_phi, A_wo)
    b = _B_ref(x, B_wqkv, B_wo)
    return g * a + (1 - g) * b
```

```asm
; @launch grid=(256,1,1) block=(512,1,1) lds=163840
.amdgcn_target "amdgcn-amd-amdhsa--gfx950"
.text
.globl gated_mix__linear_kernel_hedgehog__softmax_full_mha__prompt_kernel
.p2align 8
.type gated_mix__linear_kernel_hedgehog__softmax_full_mha__prompt_kernel,@function
gated_mix__linear_kernel_hedgehog__softmax_full_mha__prompt_kernel:
  s_cmp_ge_u32 s2, 256
  s_cbranch_scc1 L_end
  s_load_dwordx4 s[24:27], s[0:1], 0
  s_load_dwordx4 s[32:35], s[0:1], 40
  v_lshrrev_b32 v247, 6, v0
  s_load_dwordx2 s[40:41], s[0:1], 80
  v_readfirstlane_b32 s46, v247
  s_load_dwordx4 s[28:31], s[0:1], 16
  s_load_dwordx4 s[36:39], s[0:1], 56
  v_and_b32 v1, 63, v0
  s_and_b32 s58, s2, 7
  s_lshr_b32 s59, s2, 3
  s_and_b32 s44, s58, 1
  s_and_b32 s60, s59, 7
  s_lshl3_add_u32 s44, s44, s60
  s_lshr_b32 s45, s58, 1
  s_lshr_b32 s60, s59, 3
  s_lshl2_add_u32 s45, s45, s60
  s_and_b32 s47, s46, 3
  s_cmp_ge_u32 s46, 4
  s_cbranch_scc1 L_grp1
  s_mul_i32 s60, s45, 3
  s_lshl1_add_u32 s52, s44, s60
  s_mul_i32 s60, s52, 147
  s_lshr_b32 s60, s60, 10
  s_mul_i32 s60, s60, 7
  s_sub_u32 s52, s52, s60
  s_lshl_b32 s91, s52, 7
  s_lshl_b32 s56, s46, 11
  v_lshrrev_b32 v247, 3, v1
  v_and_b32 v248, 7, v1
  v_bfe_u32 v249, v1, 4, 2
  v_xor_b32 v249, v248, v249
  v_mul_u32_u24 v4, 896, v247
  v_lshl_add_u32 v4, v249, 4, v4
  s_lshl3_add_u32 s60, s45, s46
  s_mul_i32 s60, s60, 14336
  v_add_u32 v4, s60, v4
  v_add_u32 v5, 7168, v4
  v_xor_b32 v5, 64, v5
  s_mov_b32 s6, 1835008
  s_mov_b32 s7, 0x20000
  s_waitcnt lgkmcnt(0)
  s_mov_b32 s4, s24
  s_mov_b32 s5, s25
  s_add_u32 m0, s56, 0
  s_nop 0
  buffer_load_dwordx4 v4, s[4:7], s91 offen lds
  s_add_u32 m0, s56, 1024
  s_nop 0
  buffer_load_dwordx4 v5, s[4:7], s91 offen lds
  s_add_u32 m0, s56, 8192
  s_add_u32 s58, s91, 57344
  buffer_load_dwordx4 v4, s[4:7], s58 offen lds
  s_add_u32 m0, s56, 9216
  s_nop 0
  buffer_load_dwordx4 v5, s[4:7], s58 offen lds
  s_cmp_gt_u32 s44, 5
  s_subb_u32 s50, s44, 0
  s_cmp_gt_u32 s44, 10
  s_subb_u32 s50, s50, 0
  s_mul_i32 s84, s91, 1344
  s_lshl_b32 s57, s46, 10
  s_add_u32 s57, s57, 65536
  v_bfe_u32 v249, v1, 4, 1
  v_lshlrev_b32 v249, 2, v249
  v_xor_b32 v249, v248, v249
  v_mul_u32_u24 v6, 2688, v247
  v_lshl_add_u32 v6, v249, 4, v6
  s_mul_i32 s60, s46, 21504
  s_lshl_b32 s61, s50, 7
  s_add_u32 s60, s60, s61
  s_add_u32 s60, s60, 896
  v_add_u32 v6, s60, v6
  s_cmp_eq_u32 s44, 5
  s_cselect_b32 s62, 0, 1204224
  s_cmp_eq_u32 s44, 10
  s_cselect_b32 s10, 0, s62
  s_mov_b32 s11, 0x20000
  s_mov_b32 s8, s32
  s_mov_b32 s9, s33
  s_add_u32 m0, s57, 32768
  s_nop 0
  buffer_load_dwordx4 v6, s[8:11], s84 offen lds
  s_add_u32 m0, s57, 36864
  s_add_u32 s58, s84, 86016
  buffer_load_dwordx4 v6, s[8:11], s58 offen lds
  s_load_dword s51, s[40:41], 0
  s_add_u32 s92, s91, 128
  s_cmp_eq_u32 s92, 896
  s_cselect_b32 s92, 0, s92
  s_mul_i32 s85, s92, 1344
  s_add_u32 s93, s92, 128
  s_cmp_eq_u32 s93, 896
  s_cselect_b32 s93, 0, s93
  s_mul_i32 s86, s93, 1344
  s_add_u32 s94, s93, 128
  s_cmp_eq_u32 s94, 896
  s_cselect_b32 s94, 0, s94
  s_mul_i32 s87, s94, 1344
  s_add_u32 s95, s94, 128
  s_cmp_eq_u32 s95, 896
  s_cselect_b32 s95, 0, s95
  s_mul_i32 s88, s95, 1344
  s_add_u32 s96, s95, 128
  s_cmp_eq_u32 s96, 896
  s_cselect_b32 s96, 0, s96
  s_mul_i32 s89, s96, 1344
  s_add_u32 s97, s96, 128
  s_cmp_eq_u32 s97, 896
  s_cselect_b32 s97, 0, s97
  s_mul_i32 s90, s97, 1344
  s_add_u32 m0, s56, 16384
  s_nop 0
  buffer_load_dwordx4 v4, s[4:7], s92 offen lds
  s_add_u32 m0, s56, 17408
  s_nop 0
  buffer_load_dwordx4 v5, s[4:7], s92 offen lds
  s_add_u32 m0, s56, 24576
  s_add_u32 s58, s92, 57344
  buffer_load_dwordx4 v4, s[4:7], s58 offen lds
  s_add_u32 m0, s56, 25600
  s_nop 0
  buffer_load_dwordx4 v5, s[4:7], s58 offen lds
  s_add_u32 m0, s57, 40960
  s_nop 0
  buffer_load_dwordx4 v6, s[8:11], s85 offen lds
  s_add_u32 m0, s57, 45056
  s_add_u32 s58, s85, 86016
  buffer_load_dwordx4 v6, s[8:11], s58 offen lds
  v_and_b32 v2, 31, v1
  v_lshrrev_b32 v3, 5, v1
  v_bfe_u32 v247, v1, 1, 3
  v_xor_b32 v247, v247, v3
  v_lshlrev_b32 v247, 4, v247
  v_lshl_add_u32 v247, v2, 7, v247
  s_lshl_b32 s60, s47, 12
  v_add_u32 v8, s60, v247
  v_xor_b32 v9, 32, v8
  v_xor_b32 v10, 64, v8
  v_xor_b32 v11, 96, v8
  s_mov_b32 s78, 0
  s_mov_b32 s79, -1
  s_mov_b32 s12, s40
  s_mov_b32 s13, s41
  s_mov_b32 s14, 33554432
  s_mov_b32 s15, 0x20000
  s_add_u32 m0, s56, 32768
  s_nop 0
  buffer_load_dwordx4 v4, s[4:7], s93 offen lds
  s_add_u32 m0, s56, 33792
  s_nop 0
  buffer_load_dwordx4 v5, s[4:7], s93 offen lds
  s_add_u32 m0, s56, 40960
  s_add_u32 s58, s93, 57344
  buffer_load_dwordx4 v4, s[4:7], s58 offen lds
  s_add_u32 m0, s56, 41984
  s_nop 0
  buffer_load_dwordx4 v5, s[4:7], s58 offen lds
  s_add_u32 m0, s57, 49152
  s_nop 0
  buffer_load_dwordx4 v6, s[8:11], s86 offen lds
  s_add_u32 m0, s57, 53248
  s_add_u32 s58, s86, 86016
  buffer_load_dwordx4 v6, s[8:11], s58 offen lds
  s_xor_b32 s49, s44, 1
  s_mov_b32 s64, 1901081188
  s_mov_b32 s65, 3118267112
  s_lshl_b32 s60, s44, 2
  s_lshr_b64 s[64:65], s[64:65], s60
  s_and_b32 s53, s64, 15
  s_mov_b32 s20, s26
  s_mov_b32 s21, s27
  s_mov_b32 s22, 1204224
  s_mov_b32 s23, 0x20000
  s_mov_b32 s68, s32
  s_mov_b32 s69, s33
  s_mov_b32 s70, 1204224
  s_mov_b32 s71, 0x20000
  s_mul_i32 s60, s47, 43008
  v_lshrrev_b32 v247, 2, v1
  v_mul_u32_u24 v247, 2688, v247
  v_and_b32 v248, 3, v1
  v_lshl_add_u32 v247, v248, 4, v247
  v_lshrrev_b32 v249, 1, v248
  v_and_b32 v249, v249, v248
  v_lshlrev_b32 v249, 3, v249
  v_sub_u32 v247, v247, v249
  v_add_u32 v247, s60, v247
  s_mul_i32 s58, s49, 56
  s_mul_i32 s59, s53, 56
  s_mul_i32 s61, s44, 56
  s_add_u32 s58, s58, 896
  v_add_u32 v244, s58, v247
  v_add_u32 v245, s61, v247
  v_add_u32 v7, s59, v247
  v_add_u32 v13, 896, v244
  s_waitcnt vmcnt(12)
  s_waitcnt lgkmcnt(0)
  s_barrier
  ds_read_b128 v[128:131], v8 offset:0
  ds_read_b128 v[132:135], v9 offset:0
  ds_read_b128 v[136:139], v10 offset:0
  ds_read_b128 v[140:143], v11 offset:0
  s_lshl_b32 s60, s45, 2
  s_add_u32 s60, s60, s47
  s_lshl_b32 s60, s60, 16
  s_lshl_b32 s61, s44, 11
  s_add_u32 s60, s60, s61
  s_add_u32 s60, s60, 8421376
  v_lshl_add_u32 v246, v1, 4, s60
  s_add_u32 s51, s51, 0x9e3779b0
  s_lshr_b32 s60, s46, 1
  s_lshl_b32 s61, s60, 2
  v_and_b32 v247, 3, v1
  v_or_b32 v247, s61, v247
  v_bfe_u32 v248, v1, 2, 1
  v_bfe_u32 v240, v1, 4, 1
  v_lshl_or_b32 v248, v240, 1, v248
  v_bfe_u32 v241, v1, 3, 1
  v_lshl_or_b32 v248, v241, 3, v248
  v_xor_b32 v247, v247, v248
  v_bfe_u32 v248, v1, 2, 2
  v_lshl_or_b32 v248, v240, 2, v248
  v_lshl_or_b32 v248, v3, 4, v248
  v_lshlrev_b32 v247, 3, v247
  v_lshl_add_u32 v247, v248, 7, v247
  v_and_b32 v248, 15, v1
  s_and_b32 s61, s46, 1
  s_lshl_b32 s61, s61, 4
  v_add_u32 v248, s61, v248
  s_lshl3_add_u32 s61, s49, s46
  s_lshl4_add_u32 s61, s61, s45
  s_lshl_b32 s61, s61, 9
  s_add_u32 s61, s61, 5242880
  v_and_b32 v243, 15, v1
  v_lshl_or_b32 v243, v3, 4, v243
  v_lshl_or_b32 v243, v243, 1, v240
  v_lshl_add_u32 v243, v243, 3, s61
  v_lshlrev_b32 v248, 4, v248
  v_lshrrev_b32 v242, 4, v1
  v_lshl_add_u32 v242, v242, 9, v248
  v_add_u32 v242, 122880, v242
  v_add_u32 v240, 98304, v247
  v_add_u32 v241, 1024, v240
  v_xor_b32 v241, 32, v241
  s_add_u32 m0, s56, 49152
  s_nop 0
  buffer_load_dwordx4 v4, s[4:7], s94 offen lds
  s_add_u32 m0, s56, 50176
  s_nop 0
  buffer_load_dwordx4 v5, s[4:7], s94 offen lds
  s_add_u32 m0, s56, 57344
  s_add_u32 s58, s94, 57344
  buffer_load_dwordx4 v4, s[4:7], s58 offen lds
  s_add_u32 m0, s56, 58368
  s_nop 0
  buffer_load_dwordx4 v5, s[4:7], s58 offen lds
  s_add_u32 m0, s57, 57344
  s_nop 0
  buffer_load_dwordx4 v6, s[8:11], s87 offen lds
  s_add_u32 m0, s57, 61440
  s_add_u32 s58, s87, 86016
  buffer_load_dwordx4 v6, s[8:11], s58 offen lds
  s_waitcnt vmcnt(12)
  s_waitcnt lgkmcnt(0)
  s_barrier
  ds_read_b128 v[144:147], v8 offset:16384
  ds_read_b128 v[148:151], v9 offset:16384
  ds_read_b128 v[152:155], v10 offset:16384
  ds_read_b128 v[156:159], v11 offset:16384
  v_and_b32_e64 v247, 1, v1
  v_bfe_u32 v248, v1, 1, 1
  v_lshl_or_b32 v247, v247, 1, v248
  v_bfe_u32 v248, v1, 4, 1
  v_lshl_or_b32 v247, v248, 2, v247
  v_bfe_u32 v248, v1, 2, 2
  v_lshl_or_b32 v248, v3, 3, v248
  v_lshrrev_b32 v249, 1, v247
  v_lshrrev_b32 v250, 2, v247
  v_and_b32 v249, v249, v250
  v_and_b32 v249, 1, v249
  v_xor_b32 v247, v247, v249
  v_lshlrev_b32 v247, 3, v247
  v_lshl_add_u32 v247, v248, 6, v247
  v_add_u32 v12, 65536, v247
  s_add_u32 m0, s56, 0
  s_nop 0
  buffer_load_dwordx4 v4, s[4:7], s95 offen lds
  s_add_u32 m0, s56, 1024
  s_nop 0
  buffer_load_dwordx4 v5, s[4:7], s95 offen lds
  s_add_u32 m0, s56, 8192
  s_add_u32 s58, s95, 57344
  buffer_load_dwordx4 v4, s[4:7], s58 offen lds
  s_add_u32 m0, s56, 9216
  s_nop 0
  buffer_load_dwordx4 v5, s[4:7], s58 offen lds
  s_add_u32 m0, s57, 65536
  s_nop 0
  buffer_load_dwordx4 v6, s[8:11], s88 offen lds
  s_add_u32 m0, s57, 69632
  s_add_u32 s58, s88, 86016
  buffer_load_dwordx4 v6, s[8:11], s58 offen lds
  s_waitcnt vmcnt(12)
  s_waitcnt lgkmcnt(0)
  s_barrier
  ds_read_b128 v[160:163], v8 offset:32768
  ds_read_b128 v[164:167], v9 offset:32768
  ds_read_b128 v[168:171], v10 offset:32768
  ds_read_b128 v[172:175], v11 offset:32768
  v_and_b32_e64 v247, 1, v1
  v_bfe_u32 v248, v1, 1, 1
  v_lshl_or_b32 v247, v247, 1, v248
  v_bfe_u32 v248, v1, 4, 1
  v_lshl_or_b32 v247, v248, 2, v247
  v_bfe_u32 v248, v1, 2, 2
  v_lshl_or_b32 v248, v3, 3, v248
  s_and_b32 s61, s44, 1
  v_subrev_u32 v247, s61, v247
  v_and_b32 v247, 7, v247
  v_lshrrev_b32 v249, 1, v247
  v_lshrrev_b32 v250, 2, v247
  v_and_b32 v249, v249, v250
  v_and_b32 v249, 1, v249
  v_xor_b32 v247, v247, v249
  v_lshlrev_b32 v247, 3, v247
  v_lshl_add_u32 v247, v248, 6, v247
  v_add_u32 v14, 122880, v247
  s_add_u32 m0, s56, 16384
  s_nop 0
  buffer_load_dwordx4 v4, s[4:7], s96 offen lds
  s_add_u32 m0, s56, 17408
  s_nop 0
  buffer_load_dwordx4 v5, s[4:7], s96 offen lds
  s_add_u32 m0, s56, 24576
  s_add_u32 s58, s96, 57344
  buffer_load_dwordx4 v4, s[4:7], s58 offen lds
  s_add_u32 m0, s56, 25600
  s_nop 0
  buffer_load_dwordx4 v5, s[4:7], s58 offen lds
  s_add_u32 m0, s57, 73728
  s_nop 0
  buffer_load_dwordx4 v6, s[8:11], s89 offen lds
  s_add_u32 m0, s57, 77824
  s_add_u32 s58, s89, 86016
  buffer_load_dwordx4 v6, s[8:11], s58 offen lds
  s_waitcnt vmcnt(12)
  s_waitcnt lgkmcnt(0)
  s_barrier
  ds_read_b128 v[176:179], v8 offset:49152
  ds_read_b128 v[180:183], v9 offset:49152
  ds_read_b128 v[184:187], v10 offset:49152
  ds_read_b128 v[188:191], v11 offset:49152
  s_add_u32 m0, s56, 32768
  s_nop 0
  buffer_load_dwordx4 v4, s[4:7], s97 offen lds
  s_add_u32 m0, s56, 33792
  s_nop 0
  buffer_load_dwordx4 v5, s[4:7], s97 offen lds
  s_add_u32 m0, s56, 40960
  s_add_u32 s58, s97, 57344
  buffer_load_dwordx4 v4, s[4:7], s58 offen lds
  s_add_u32 m0, s56, 41984
  s_nop 0
  buffer_load_dwordx4 v5, s[4:7], s58 offen lds
  s_add_u32 m0, s57, 81920
  s_nop 0
  buffer_load_dwordx4 v6, s[8:11], s90 offen lds
  s_add_u32 m0, s57, 86016
  s_add_u32 s58, s90, 86016
  buffer_load_dwordx4 v6, s[8:11], s58 offen lds
  s_add_u32 m0, s57, 0
  s_nop 0
  buffer_load_dwordx4 v7, s[20:23], s84 offen lds
  s_add_u32 m0, s57, 28672
  s_nop 0
  buffer_load_dwordx4 v244, s[20:23], s84 offen lds
  s_waitcnt vmcnt(14)
  s_waitcnt lgkmcnt(0)
  s_barrier
  ds_read_b128 v[192:195], v8 offset:0
  ds_read_b128 v[196:199], v9 offset:0
  ds_read_b128 v[200:203], v10 offset:0
  ds_read_b128 v[204:207], v11 offset:0
  s_mov_b32 s4, s36
  s_mov_b32 s5, s37
  s_mov_b32 s6, 896
  s_mov_b32 s7, 0x20000
  v_lshrrev_b32 v247, 4, v1
  v_add_u32 v247, s52, v247
  v_and_b32 v249, 15, v1
  v_lshlrev_b32 v249, 1, v249
  s_lshl_b32 s60, s47, 5
  v_add_u32 v249, s60, v249
  v_mov_b32 v5, 0
  v_mov_b32 v255, 0
  v_add_u32 v248, 0, v247
  v_subrev_u32 v250, 7, v248
  v_min_u32 v248, v248, v250
  v_lshl_add_u32 v248, v248, 7, v249
  buffer_load_ushort v4, v248, s[4:7], 0 offen
  v_add_u32 v248, 4, v247
  v_subrev_u32 v250, 7, v248
  v_min_u32 v248, v248, v250
  v_lshl_add_u32 v248, v248, 7, v249
  buffer_load_ushort v254, v248, s[4:7], 0 offen
  v_and_b32 v15, 15, v1
  v_lshlrev_b32 v15, 6, v15
  v_lshrrev_b32 v247, 4, v1
  v_lshl_add_u32 v15, v247, 12, v15
  s_add_u32 s60, s57, 48
  v_add_u32 v15, s60, v15
  s_add_u32 m0, s57, 57344
  s_nop 0
  buffer_load_dwordx4 v245, s[68:71], s84 offen lds
  s_add_u32 m0, s57, 61440
  s_nop 0
  buffer_load_dwordx4 v13, s[20:23], s84 offen lds
  s_add_u32 m0, s57, 4096
  s_nop 0
  buffer_load_dwordx4 v7, s[20:23], s85 offen lds
  s_add_u32 m0, s57, 8192
  s_nop 0
  buffer_load_dwordx4 v7, s[20:23], s86 offen lds
  s_waitcnt vmcnt(14)
  s_waitcnt lgkmcnt(0)
  s_barrier
  ds_read_b128 v[208:211], v8 offset:16384
  ds_read_b128 v[212:215], v9 offset:16384
  ds_read_b128 v[216:219], v10 offset:16384
  ds_read_b128 v[220:223], v11 offset:16384
  s_mov_b32 s4, s28
  s_mov_b32 s5, s29
  s_mov_b32 s6, 25088
  s_mov_b32 s7, 0x20000
  s_lshl_b32 s60, s47, 3
  v_lshrrev_b32 v248, 3, v1
  v_add_u32 v248, s60, v248
  v_add_u32 v249, 1, v1
  v_and_b32 v249, 7, v249
  v_max_u32 v249, 1, v249
  v_mul_u32_u24 v250, 56, v248
  v_lshl_add_u32 v250, v249, 3, v250
  v_add_u32 v248, 4, v248
  v_lshrrev_b32 v248, 5, v248
  v_subrev_u32 v250, 8, v250
  v_lshl_or_b32 v250, v248, 30, v250
  s_mul_i32 s60, s49, 1568
  s_mul_i32 s61, s53, 1568
  buffer_load_dwordx2 v[80:81], v250, s[4:7], s60 offen
  buffer_load_dwordx2 v[82:83], v250, s[4:7], s61 offen
  s_add_u32 m0, s57, 12288
  s_nop 0
  buffer_load_dwordx4 v7, s[20:23], s87 offen lds
  s_add_u32 m0, s57, 16384
  s_nop 0
  buffer_load_dwordx4 v7, s[20:23], s88 offen lds
  s_waitcnt vmcnt(12)
  s_waitcnt lgkmcnt(0)
  s_barrier
  ds_read_b128 v[224:227], v8 offset:32768
  ds_read_b128 v[228:231], v9 offset:32768
  ds_read_b128 v[232:235], v10 offset:32768
  ds_read_b128 v[236:239], v11 offset:32768
  s_add_u32 m0, s57, 20480
  s_nop 0
  buffer_load_dwordx4 v7, s[20:23], s89 offen lds
  s_add_u32 m0, s57, 24576
  s_nop 0
  buffer_load_dwordx4 v7, s[20:23], s90 offen lds
  s_waitcnt vmcnt(3)
  ds_write_b64 v15, v[4:5] offset:0
  s_waitcnt lgkmcnt(0)
  s_barrier
  ds_read_b64_tr_b16 v[112:113], v12 offset:0
  ds_read_b64_tr_b16 v[114:115], v12 offset:256
  ds_read_b64_tr_b16 v[116:117], v12 offset:1024
  ds_read_b64_tr_b16 v[118:119], v12 offset:1280
  ds_read_b64_tr_b16 v[120:121], v12 offset:2048
  ds_read_b64_tr_b16 v[122:123], v12 offset:2304
  ds_read_b64_tr_b16 v[124:125], v12 offset:3072
  ds_read_b64_tr_b16 v[126:127], v12 offset:3328
  s_add_u32 m0, s57, 32768
  s_nop 0
  buffer_load_dwordx4 v244, s[20:23], s85 offen lds
  s_add_u32 m0, s57, 36864
  s_nop 0
  buffer_load_dwordx4 v244, s[20:23], s86 offen lds
  s_waitcnt lgkmcnt(0)
  s_nop 0
  v_mfma_f32_32x32x16_bf16 v[32:47], v[112:115], v[128:131], 0
  ds_read_b64_tr_b16 v[96:97], v12 offset:4096
  ds_read_b64_tr_b16 v[98:99], v12 offset:4352
  ds_read_b64_tr_b16 v[100:101], v12 offset:5120
  ds_read_b64_tr_b16 v[102:103], v12 offset:5376
  v_mfma_f32_32x32x16_bf16 v[32:47], v[116:119], v[132:135], v[32:47]
  ds_read_b64_tr_b16 v[104:105], v12 offset:6144
  ds_read_b64_tr_b16 v[106:107], v12 offset:6400
  ds_read_b64_tr_b16 v[108:109], v12 offset:7168
  ds_read_b64_tr_b16 v[110:111], v12 offset:7424
  v_mfma_f32_32x32x16_bf16 v[32:47], v[120:123], v[136:139], v[32:47]
  v_mfma_f32_32x32x16_bf16 v[32:47], v[124:127], v[140:143], v[32:47]
  s_waitcnt lgkmcnt(0)
  s_nop 0
  v_mfma_f32_32x32x16_bf16 v[32:47], v[96:99], v[144:147], v[32:47]
  ds_read_b64_tr_b16 v[112:113], v12 offset:8192
  ds_read_b64_tr_b16 v[114:115], v12 offset:8448
  ds_read_b64_tr_b16 v[116:117], v12 offset:9216
  ds_read_b64_tr_b16 v[118:119], v12 offset:9472
  v_mfma_f32_32x32x16_bf16 v[32:47], v[100:103], v[148:151], v[32:47]
  ds_read_b64_tr_b16 v[120:121], v12 offset:10240
  ds_read_b64_tr_b16 v[122:123], v12 offset:10496
  ds_read_b64_tr_b16 v[124:125], v12 offset:11264
  ds_read_b64_tr_b16 v[126:127], v12 offset:11520
  v_mfma_f32_32x32x16_bf16 v[32:47], v[104:107], v[152:155], v[32:47]
  s_lshl_b32 s60, s47, 9
  s_add_u32 s60, s60, 155648
  v_lshl_add_u32 v247, v1, 3, s60
  ds_write_b64 v247, v[80:81]
  ds_write_b64 v247, v[82:83] offset:2048
  v_mfma_f32_32x32x16_bf16 v[32:47], v[108:111], v[156:159], v[32:47]
  s_add_u32 m0, s57, 40960
  s_nop 0
  buffer_load_dwordx4 v244, s[20:23], s87 offen lds
  s_add_u32 m0, s57, 45056
  s_nop 0
  buffer_load_dwordx4 v244, s[20:23], s88 offen lds
  s_waitcnt lgkmcnt(0)
  v_mfma_f32_32x32x16_bf16 v[32:47], v[112:115], v[160:163], v[32:47]
  ds_read_b64_tr_b16 v[96:97], v12 offset:12288
  ds_read_b64_tr_b16 v[98:99], v12 offset:12544
  ds_read_b64_tr_b16 v[100:101], v12 offset:13312
  ds_read_b64_tr_b16 v[102:103], v12 offset:13568
  v_mfma_f32_32x32x16_bf16 v[32:47], v[116:119], v[164:167], v[32:47]
  ds_read_b64_tr_b16 v[104:105], v12 offset:14336
  ds_read_b64_tr_b16 v[106:107], v12 offset:14592
  ds_read_b64_tr_b16 v[108:109], v12 offset:15360
  ds_read_b64_tr_b16 v[110:111], v12 offset:15616
  v_mfma_f32_32x32x16_bf16 v[32:47], v[120:123], v[168:171], v[32:47]
  v_mfma_f32_32x32x16_bf16 v[32:47], v[124:127], v[172:175], v[32:47]
  s_waitcnt vmcnt(4)
  ds_write_b64 v15, v[254:255] offset:16384
  s_waitcnt lgkmcnt(0)
  s_barrier
  s_nop 0
  v_mfma_f32_32x32x16_bf16 v[32:47], v[96:99], v[176:179], v[32:47]
  ds_read_b64_tr_b16 v[112:113], v12 offset:16384
  ds_read_b64_tr_b16 v[114:115], v12 offset:16640
  ds_read_b64_tr_b16 v[116:117], v12 offset:17408
  ds_read_b64_tr_b16 v[118:119], v12 offset:17664
  v_mfma_f32_32x32x16_bf16 v[32:47], v[100:103], v[180:183], v[32:47]
  ds_read_b64_tr_b16 v[120:121], v12 offset:18432
  ds_read_b64_tr_b16 v[122:123], v12 offset:18688
  ds_read_b64_tr_b16 v[124:125], v12 offset:19456
  ds_read_b64_tr_b16 v[126:127], v12 offset:19712
  v_mfma_f32_32x32x16_bf16 v[32:47], v[104:107], v[184:187], v[32:47]
  v_mfma_f32_32x32x16_bf16 v[32:47], v[108:111], v[188:191], v[32:47]
  s_add_u32 m0, s57, 49152
  s_nop 0
  buffer_load_dwordx4 v244, s[20:23], s89 offen lds
  s_add_u32 m0, s57, 53248
  s_nop 0
  buffer_load_dwordx4 v244, s[20:23], s90 offen lds
  s_waitcnt lgkmcnt(0)
  s_nop 0
  v_mfma_f32_32x32x16_bf16 v[32:47], v[112:115], v[192:195], v[32:47]
  ds_read_b64_tr_b16 v[96:97], v12 offset:20480
  ds_read_b64_tr_b16 v[98:99], v12 offset:20736
  ds_read_b64_tr_b16 v[100:101], v12 offset:21504
  ds_read_b64_tr_b16 v[102:103], v12 offset:21760
  v_mfma_f32_32x32x16_bf16 v[32:47], v[116:119], v[196:199], v[32:47]
  ds_read_b64_tr_b16 v[104:105], v12 offset:22528
  ds_read_b64_tr_b16 v[106:107], v12 offset:22784
  ds_read_b64_tr_b16 v[108:109], v12 offset:23552
  ds_read_b64_tr_b16 v[110:111], v12 offset:23808
  v_mfma_f32_32x32x16_bf16 v[32:47], v[120:123], v[200:203], v[32:47]
  v_and_b32_e64 v247, 3, v1
  v_bfe_u32 v248, v1, 4, 1
  v_lshl_or_b32 v247, v248, 2, v247
  v_bfe_u32 v248, v1, 2, 2
  v_lshl_or_b32 v248, v3, 3, v248
  v_lshrrev_b32 v249, 1, v247
  v_lshrrev_b32 v250, 2, v247
  v_and_b32 v249, v249, v250
  v_and_b32 v249, 1, v249
  v_xor_b32 v247, v247, v249
  v_lshlrev_b32 v247, 3, v247
  v_lshl_add_u32 v247, v248, 6, v247
  v_add_u32 v11, 126976, v247
  v_mfma_f32_32x32x16_bf16 v[32:47], v[124:127], v[204:207], v[32:47]
  s_waitcnt lgkmcnt(0)
  s_nop 0
  v_mfma_f32_32x32x16_bf16 v[32:47], v[96:99], v[208:211], v[32:47]
  ds_read_b64_tr_b16 v[112:113], v12 offset:24576
  ds_read_b64_tr_b16 v[114:115], v12 offset:24832
  ds_read_b64_tr_b16 v[116:117], v12 offset:25600
  ds_read_b64_tr_b16 v[118:119], v12 offset:25856
  v_mfma_f32_32x32x16_bf16 v[32:47], v[100:103], v[212:215], v[32:47]
  ds_read_b64_tr_b16 v[120:121], v12 offset:26624
  ds_read_b64_tr_b16 v[122:123], v12 offset:26880
  ds_read_b64_tr_b16 v[124:125], v12 offset:27648
  ds_read_b64_tr_b16 v[126:127], v12 offset:27904
  v_mfma_f32_32x32x16_bf16 v[32:47], v[104:107], v[216:219], v[32:47]
  v_and_b32_e64 v247, 3, v1
  v_bfe_u32 v248, v1, 4, 1
  v_lshl_or_b32 v247, v248, 2, v247
  v_bfe_u32 v248, v1, 2, 2
  v_lshl_or_b32 v248, v3, 3, v248
  v_lshlrev_b32_e64 v247, 3, v247
  v_lshl_add_u32 v247, v248, 6, v247
  v_add_u32 v247, 157696, v247
  ds_read_b64_tr_b16 v[80:81], v247 offset:0
  ds_read_b64_tr_b16 v[82:83], v247 offset:256
  ds_read_b64_tr_b16 v[84:85], v247 offset:1024
  ds_read_b64_tr_b16 v[86:87], v247 offset:1280
  s_mov_b32 s80, 0x3fb8aa3b
  v_mfma_f32_32x32x16_bf16 v[32:47], v[108:111], v[220:223], v[32:47]
  s_waitcnt vmcnt(4)
  s_waitcnt lgkmcnt(0)
  s_barrier
  v_mfma_f32_32x32x16_bf16 v[32:47], v[112:115], v[224:227], v[32:47]
  s_lshl_b32 s74, s46, 12
  s_lshl_b32 s60, s44, 18
  s_lshl_b32 s61, s47, 12
  s_add_u32 s60, s60, s61
  s_add_u32 s60, s60, 1048576
  v_lshl_add_u32 v12, v1, 4, s60
  v_mfma_f32_32x32x16_bf16 v[32:47], v[116:119], v[228:231], v[32:47]
  v_lshlrev_b32 v8, 4, v1
  v_add_u32 v8, 0, v8
  v_add_u32 v9, 0x10000, v8
  v_mov_b32 v10, 0xdddddddd
  v_mfma_f32_32x32x16_bf16 v[32:47], v[120:123], v[232:235], v[32:47]
  s_mul_i32 s60, s44, 28
  s_add_u32 s61, s60, 27
  s_lshr_b32 s60, s60, 6
  s_lshr_b32 s61, s61, 6
  s_sub_u32 s61, s61, s60
  v_bfe_u32 v252, v1, 3, 1
  v_mul_u32_u24 v252, s61, v252
  v_bfe_u32 v253, v1, 4, 1
  v_mul_u32_u24 v253, 7, v253
  v_add3_u32 v252, v252, v253, s60
  s_lshr_b32 s60, s45, 1
  s_and_b32 s61, s45, 1
  s_lshl2_add_u32 s77, s61, s60
  v_add_u32 v253, s77, v1
  v_and_b32 v253, 7, v253
  v_lshl_add_u32 v252, v252, 4, v253
  s_lshl_b32 s60, s47, 6
  s_add_u32 s60, s60, 262144
  v_lshl_add_u32 v5, v252, 8, s60
  s_and_b32 s73, s77, 7
  s_lshl_b32 s73, s73, 14
  v_mfma_f32_32x32x16_bf16 v[32:47], v[124:127], v[236:239], v[32:47]
  s_nop 11
  s_nop 0
  v_cvt_pk_bf16_f32 v88, v32, v33
  v_cvt_pk_bf16_f32 v89, v34, v35
  v_cvt_pk_bf16_f32 v90, v36, v37
  v_cvt_pk_bf16_f32 v91, v38, v39
  v_cvt_pk_bf16_f32 v92, v40, v41
  v_cvt_pk_bf16_f32 v93, v42, v43
  v_cvt_pk_bf16_f32 v94, v44, v45
  v_cvt_pk_bf16_f32 v95, v46, v47
  v_mov_b32 v252, v44
  v_mov_b32 v15, v44
  v_mfma_f32_32x32x16_bf16 v[48:63], v[80:83], v[88:91], 0
  v_mfma_f32_32x32x16_bf16 v[48:63], v[84:87], v[92:95], v[48:63]
  v_permlane32_swap_b32 v252, v15
  v_mul_f32 v15, 0xbfb8aa3b, v15
  v_exp_f32 v15, v15
  s_nop 0
  v_add_f32 v15, 1.0, v15
  v_rcp_f32 v15, v15
  s_nop 5
  v_cvt_pk_bf16_f32 v64, v48, v49
  v_cvt_pk_bf16_f32 v65, v50, v51
  v_cvt_pk_bf16_f32 v66, v52, v53
  v_cvt_pk_bf16_f32 v67, v54, v55
  v_cvt_pk_bf16_f32 v68, v56, v57
  v_cvt_pk_bf16_f32 v69, v58, v59
  v_cvt_pk_bf16_f32 v70, v60, v61
  v_cvt_pk_bf16_f32 v71, v62, v63
  v_lshlrev_b32 v48, 16, v64
  v_and_b32 v49, 0xffff0000, v64
  v_lshlrev_b32 v50, 16, v65
  v_and_b32 v51, 0xffff0000, v65
  v_lshlrev_b32 v52, 16, v66
  v_and_b32 v53, 0xffff0000, v66
  v_lshlrev_b32 v54, 16, v67
  v_and_b32 v55, 0xffff0000, v67
  v_lshlrev_b32 v56, 16, v68
  v_and_b32 v57, 0xffff0000, v68
  v_lshlrev_b32 v58, 16, v69
  v_and_b32 v59, 0xffff0000, v69
  v_lshlrev_b32 v60, 16, v70
  v_and_b32 v61, 0xffff0000, v70
  v_lshlrev_b32 v62, 16, v71
  v_and_b32 v63, 0xffff0000, v71
  v_max3_f32 v247, v48, v49, v50
  v_max3_f32 v248, -v48, -v49, -v50
  v_max3_f32 v247, v247, v51, v52
  v_max3_f32 v248, v248, -v51, -v52
  v_max3_f32 v247, v247, v53, v54
  v_max3_f32 v248, v248, -v53, -v54
  v_max3_f32 v247, v247, v55, v56
  v_max3_f32 v248, v248, -v55, -v56
  v_max3_f32 v247, v247, v57, v58
  v_max3_f32 v248, v248, -v57, -v58
  v_max3_f32 v247, v247, v59, v60
  v_max3_f32 v248, v248, -v59, -v60
  v_max3_f32 v247, v247, v61, v62
  v_max3_f32 v248, v248, -v61, -v62
  v_max_f32 v247, v247, v63
  v_max_f32_e64 v248, v248, -v63
  v_sub_u32 v249, 0, v3
  v_and_b32 v249, 0x7f800000, v249
  v_permlane32_swap_b32 v247, v248
  v_max_f32 v247, v247, v248
  v_mul_f32 v248, s80, v247
  v_mul_f32 v250, s80, v247
  s_nop 1
  v_permlane32_swap_b32 v248, v250
  v_fma_f32 v64, v48, s80, -v248
  v_fma_f32 v65, v49, s80, -v248
  v_fma_f32 v80, -v48, s80, -v250
  v_fma_f32 v81, -v49, s80, -v250
  v_fma_f32 v66, v50, s80, -v248
  v_fma_f32 v67, v51, s80, -v248
  v_fma_f32 v82, -v50, s80, -v250
  v_fma_f32 v83, -v51, s80, -v250
  v_fma_f32 v68, v52, s80, -v248
  v_fma_f32 v69, v53, s80, -v248
  v_fma_f32 v84, -v52, s80, -v250
  v_fma_f32 v85, -v53, s80, -v250
  v_fma_f32 v70, v54, s80, -v248
  v_fma_f32 v71, v55, s80, -v248
  v_fma_f32 v86, -v54, s80, -v250
  v_fma_f32 v87, -v55, s80, -v250
  v_fma_f32 v72, v56, s80, -v248
  v_fma_f32 v73, v57, s80, -v248
  v_fma_f32 v88, -v56, s80, -v250
  v_fma_f32 v89, -v57, s80, -v250
  v_fma_f32 v74, v58, s80, -v248
  v_fma_f32 v75, v59, s80, -v248
  v_fma_f32 v90, -v58, s80, -v250
  v_fma_f32 v91, -v59, s80, -v250
  s_waitcnt vmcnt(0)
  s_waitcnt lgkmcnt(0)
  s_barrier
  v_add_f32 v248, v248, v249
  v_add_f32_e64 v250, v250, v249
  v_fma_f32 v76, v60, s80, -v248
  v_fma_f32 v77, v61, s80, -v248
  v_fma_f32 v92, -v60, s80, -v250
  v_fma_f32 v93, -v61, s80, -v250
  v_fma_f32 v78, v62, s80, -v248
  v_fma_f32 v79, v63, s80, -v248
  v_fma_f32 v94, -v62, s80, -v250
  v_fma_f32 v95, -v63, s80, -v250
  v_exp_f32 v64, v64
  v_exp_f32 v65, v65
  v_exp_f32 v66, v66
  v_exp_f32 v67, v67
  v_exp_f32 v68, v68
  v_exp_f32 v69, v69
  v_exp_f32 v70, v70
  v_exp_f32 v71, v71
  v_exp_f32 v72, v72
  v_exp_f32 v73, v73
  v_exp_f32 v74, v74
  v_exp_f32 v75, v75
  v_exp_f32 v76, v76
  v_exp_f32 v77, v77
  v_exp_f32 v78, v78
  v_exp_f32 v79, v79
  v_exp_f32 v80, v80
  v_exp_f32 v81, v81
  v_exp_f32 v82, v82
  v_exp_f32 v83, v83
  v_exp_f32 v84, v84
  v_exp_f32 v85, v85
  v_exp_f32 v86, v86
  v_exp_f32 v87, v87
  v_exp_f32 v88, v88
  v_exp_f32 v89, v89
  v_exp_f32 v90, v90
  v_exp_f32 v91, v91
  v_exp_f32 v92, v92
  v_exp_f32 v93, v93
  v_exp_f32 v94, v94
  v_exp_f32 v95, v95
  v_add_f32 v248, v64, v66
  v_add_f32 v249, v65, v67
  v_add_f32 v250, v80, v82
  v_add_f32 v251, v81, v83
  v_add_f32 v248, v248, v68
  v_add_f32 v249, v249, v69
  v_add_f32 v250, v250, v84
  v_add_f32 v251, v251, v85
  v_add_f32 v248, v248, v70
  v_add_f32 v249, v249, v71
  v_add_f32 v250, v250, v86
  v_add_f32 v251, v251, v87
  v_add_f32 v248, v248, v72
  v_add_f32 v249, v249, v73
  v_add_f32 v250, v250, v88
  v_add_f32 v251, v251, v89
  v_add_f32 v248, v248, v74
  v_add_f32 v249, v249, v75
  v_add_f32 v250, v250, v90
  v_add_f32 v251, v251, v91
  v_add_f32 v248, v248, v76
  v_add_f32 v249, v249, v77
  v_add_f32 v250, v250, v92
  v_add_f32 v251, v251, v93
  v_add_f32 v248, v248, v78
  v_add_f32 v249, v249, v79
  v_add_f32 v250, v250, v94
  v_add_f32 v251, v251, v95
  v_add_f32 v248, v248, v249
  v_add_f32 v250, v250, v251
  s_nop 1
  v_permlane32_swap_b32 v248, v250
  v_add_f32 v248, v248, v250
  v_mov_b32 v250, v248
  s_nop 1
  v_permlane32_swap_b32 v248, v250
  v_rcp_f32 v250, v250
  v_mul_f32 v6, 0x358637bd, v248
  v_mul_f32 v250, v250, v248
  v_mul_f32 v80, v80, v250
  v_mul_f32 v81, v81, v250
  v_mul_f32 v82, v82, v250
  v_mul_f32 v83, v83, v250
  v_mul_f32 v84, v84, v250
  v_mul_f32 v85, v85, v250
  v_mul_f32 v86, v86, v250
  v_mul_f32 v87, v87, v250
  v_mul_f32 v88, v88, v250
  v_mul_f32 v89, v89, v250
  v_mul_f32 v90, v90, v250
  v_mul_f32 v91, v91, v250
  v_mul_f32 v92, v92, v250
  v_mul_f32 v93, v93, v250
  v_mul_f32 v94, v94, v250
  v_mul_f32 v95, v95, v250
  v_cvt_pk_bf16_f32 v32, v64, v65
  v_cvt_pk_bf16_f32 v40, v80, v81
  v_cvt_pk_bf16_f32 v33, v66, v67
  v_cvt_pk_bf16_f32 v41, v82, v83
  v_cvt_pk_bf16_f32 v34, v68, v69
  v_cvt_pk_bf16_f32 v42, v84, v85
  v_cvt_pk_bf16_f32 v35, v70, v71
  v_cvt_pk_bf16_f32 v43, v86, v87
  v_cvt_pk_bf16_f32 v36, v72, v73
  v_cvt_pk_bf16_f32 v44, v88, v89
  v_cvt_pk_bf16_f32 v37, v74, v75
  v_cvt_pk_bf16_f32 v45, v90, v91
  v_cvt_pk_bf16_f32 v38, v76, v77
  v_cvt_pk_bf16_f32 v46, v92, v93
  v_cvt_pk_bf16_f32 v39, v78, v79
  v_cvt_pk_bf16_f32 v47, v94, v95
  s_waitcnt lgkmcnt(0)
  s_barrier
  ds_read_b64_tr_b16 v[112:113], v14 offset:0
  ds_read_b64_tr_b16 v[114:115], v14 offset:256
  ds_read_b64_tr_b16 v[80:81], v11 offset:0
  ds_read_b64_tr_b16 v[82:83], v11 offset:256
  ds_read_b64_tr_b16 v[116:117], v14 offset:1024
  ds_read_b64_tr_b16 v[118:119], v14 offset:1280
  ds_read_b64_tr_b16 v[84:85], v11 offset:1024
  ds_read_b64_tr_b16 v[86:87], v11 offset:1280
  ds_read_b64_tr_b16 v[120:121], v14 offset:2048
  ds_read_b64_tr_b16 v[122:123], v14 offset:2304
  ds_read_b64_tr_b16 v[88:89], v11 offset:2048
  ds_read_b64_tr_b16 v[90:91], v11 offset:2304
  ds_read_b64_tr_b16 v[124:125], v14 offset:3072
  ds_read_b64_tr_b16 v[126:127], v14 offset:3328
  ds_read_b64_tr_b16 v[92:93], v11 offset:3072
  ds_read_b64_tr_b16 v[94:95], v11 offset:3328
  s_waitcnt lgkmcnt(0)
  s_nop 0
  v_mfma_f32_32x32x16_bf16 v[16:31], v[112:115], v[128:131], 0
  ds_read_b64_tr_b16 v[96:97], v14 offset:8192
  ds_read_b64_tr_b16 v[98:99], v14 offset:8448
  v_mfma_f32_32x32x16_bf16 v[64:79], v[128:131], v[80:83], 0
  ds_read_b64_tr_b16 v[48:49], v11 offset:8192
  ds_read_b64_tr_b16 v[50:51], v11 offset:8448
  ds_read_b64_tr_b16 v[100:101], v14 offset:9216
  v_mfma_f32_32x32x16_bf16 v[16:31], v[116:119], v[132:135], v[16:31]
  ds_read_b64_tr_b16 v[102:103], v14 offset:9472
  ds_read_b64_tr_b16 v[52:53], v11 offset:9216
  ds_read_b64_tr_b16 v[54:55], v11 offset:9472
  v_mfma_f32_32x32x16_bf16 v[64:79], v[132:135], v[84:87], v[64:79]
  ds_read_b64_tr_b16 v[104:105], v14 offset:10240
  ds_read_b64_tr_b16 v[106:107], v14 offset:10496
  v_mfma_f32_32x32x16_bf16 v[16:31], v[120:123], v[136:139], v[16:31]
  ds_read_b64_tr_b16 v[56:57], v11 offset:10240
  ds_read_b64_tr_b16 v[58:59], v11 offset:10496
  ds_read_b64_tr_b16 v[108:109], v14 offset:11264
  v_mfma_f32_32x32x16_bf16 v[64:79], v[136:139], v[88:91], v[64:79]
  ds_read_b64_tr_b16 v[110:111], v14 offset:11520
  ds_read_b64_tr_b16 v[60:61], v11 offset:11264
  ds_read_b64_tr_b16 v[62:63], v11 offset:11520
  v_mfma_f32_32x32x16_bf16 v[16:31], v[124:127], v[140:143], v[16:31]
  v_mfma_f32_32x32x16_bf16 v[64:79], v[140:143], v[92:95], v[64:79]
  buffer_load_dword v4, v5, s[12:15], 0 offen sc1
  s_waitcnt lgkmcnt(0)
  s_barrier
  v_mfma_f32_32x32x16_bf16 v[16:31], v[96:99], v[144:147], v[16:31]
  ds_read_b64_tr_b16 v[112:113], v14 offset:16384
  ds_read_b64_tr_b16 v[114:115], v14 offset:16640
  v_mfma_f32_32x32x16_bf16 v[64:79], v[144:147], v[48:51], v[64:79]
  ds_read_b64_tr_b16 v[80:81], v11 offset:16384
  ds_read_b64_tr_b16 v[82:83], v11 offset:16640
  ds_read_b64_tr_b16 v[116:117], v14 offset:17408
  v_mfma_f32_32x32x16_bf16 v[16:31], v[100:103], v[148:151], v[16:31]
  ds_read_b64_tr_b16 v[118:119], v14 offset:17664
  ds_read_b64_tr_b16 v[84:85], v11 offset:17408
  ds_read_b64_tr_b16 v[86:87], v11 offset:17664
  v_mfma_f32_32x32x16_bf16 v[64:79], v[148:151], v[52:55], v[64:79]
  ds_read_b64_tr_b16 v[120:121], v14 offset:18432
  ds_read_b64_tr_b16 v[122:123], v14 offset:18688
  v_mfma_f32_32x32x16_bf16 v[16:31], v[104:107], v[152:155], v[16:31]
  ds_read_b64_tr_b16 v[88:89], v11 offset:18432
  ds_read_b64_tr_b16 v[90:91], v11 offset:18688
  ds_read_b64_tr_b16 v[124:125], v14 offset:19456
  s_lshl_b32 s60, s47, 11
  s_add_u32 s60, s60, 114688
  v_lshl_add_u32 v7, v1, 4, s60
  v_mfma_f32_32x32x16_bf16 v[64:79], v[152:155], v[56:59], v[64:79]
  ds_read_b64_tr_b16 v[126:127], v14 offset:19712
  ds_read_b64_tr_b16 v[92:93], v11 offset:19456
  ds_read_b64_tr_b16 v[94:95], v11 offset:19712
  v_mfma_f32_32x32x16_bf16 v[16:31], v[108:111], v[156:159], v[16:31]
  v_mfma_f32_32x32x16_bf16 v[64:79], v[156:159], v[60:63], v[64:79]
  s_waitcnt lgkmcnt(0)
  v_mfma_f32_32x32x16_bf16 v[16:31], v[112:115], v[160:163], v[16:31]
  ds_read_b64_tr_b16 v[96:97], v14 offset:24576
  ds_read_b64_tr_b16 v[98:99], v14 offset:24832
  v_mfma_f32_32x32x16_bf16 v[64:79], v[160:163], v[80:83], v[64:79]
  ds_read_b64_tr_b16 v[48:49], v11 offset:24576
  ds_read_b64_tr_b16 v[50:51], v11 offset:24832
  ds_read_b64_tr_b16 v[100:101], v14 offset:25600
  v_mfma_f32_32x32x16_bf16 v[16:31], v[116:119], v[164:167], v[16:31]
  ds_read_b64_tr_b16 v[102:103], v14 offset:25856
  ds_read_b64_tr_b16 v[52:53], v11 offset:25600
  ds_read_b64_tr_b16 v[54:55], v11 offset:25856
  v_mfma_f32_32x32x16_bf16 v[64:79], v[164:167], v[84:87], v[64:79]
  ds_read_b64_tr_b16 v[104:105], v14 offset:26624
  ds_read_b64_tr_b16 v[106:107], v14 offset:26880
  v_mfma_f32_32x32x16_bf16 v[16:31], v[120:123], v[168:171], v[16:31]
  ds_read_b64_tr_b16 v[56:57], v11 offset:26624
  ds_read_b64_tr_b16 v[58:59], v11 offset:26880
  ds_read_b64_tr_b16 v[108:109], v14 offset:27648
  v_mfma_f32_32x32x16_bf16 v[64:79], v[168:171], v[88:91], v[64:79]
  ds_read_b64_tr_b16 v[110:111], v14 offset:27904
  ds_read_b64_tr_b16 v[60:61], v11 offset:27648
  ds_read_b64_tr_b16 v[62:63], v11 offset:27904
  v_mfma_f32_32x32x16_bf16 v[16:31], v[124:127], v[172:175], v[16:31]
  v_mfma_f32_32x32x16_bf16 v[64:79], v[172:175], v[92:95], v[64:79]
  s_waitcnt vmcnt(0)
  v_cmp_eq_u32 vcc, s51, v4
  s_nop 0
  s_lshr_b32 s76, vcc_lo, 16
  s_and_b32 s76, s76, vcc_lo
  s_lshr_b32 s58, s76, 8
  s_and_b32 s76, s76, s58
  s_and_b32 s76, s76, 0xff
  s_bitcmp1_b32 s76, 0
  s_cbranch_scc0 L_kp_1
L_kpd_2:
  s_add_u32 m0, s74, 0
  s_nop 0
  buffer_load_dwordx4 v12, s[12:15], s73 offen offset:0 sc1 lds
  s_add_u32 m0, s74, 0
  s_nop 0
  buffer_load_dwordx4 v12, s[12:15], s73 offen offset:1024 sc1 lds
  s_waitcnt lgkmcnt(0)
  s_barrier
  s_nop 0
  v_mfma_f32_32x32x16_bf16 v[16:31], v[96:99], v[176:179], v[16:31]
  v_subrev_u32 v14, 57344, v14
  v_subrev_u32 v11, 57344, v11
  ds_read_b64_tr_b16 v[112:113], v14 offset:0
  v_mfma_f32_32x32x16_bf16 v[64:79], v[176:179], v[48:51], v[64:79]
  ds_read_b64_tr_b16 v[114:115], v14 offset:256
  ds_read_b64_tr_b16 v[80:81], v11 offset:0
  ds_read_b64_tr_b16 v[82:83], v11 offset:256
  v_mfma_f32_32x32x16_bf16 v[16:31], v[100:103], v[180:183], v[16:31]
  ds_read_b64_tr_b16 v[116:117], v14 offset:1024
  ds_read_b64_tr_b16 v[118:119], v14 offset:1280
  ds_read_b64_tr_b16 v[84:85], v11 offset:1024
  v_mfma_f32_32x32x16_bf16 v[64:79], v[180:183], v[52:55], v[64:79]
  ds_read_b64_tr_b16 v[86:87], v11 offset:1280
  ds_read_b64_tr_b16 v[120:121], v14 offset:2048
  ds_read_b64_tr_b16 v[122:123], v14 offset:2304
  v_mfma_f32_32x32x16_bf16 v[16:31], v[104:107], v[184:187], v[16:31]
  ds_read_b64_tr_b16 v[88:89], v11 offset:2048
  ds_read_b64_tr_b16 v[90:91], v11 offset:2304
  ds_read_b64_tr_b16 v[124:125], v14 offset:3072
  s_lshr_b32 s60, s44, 3
  s_lshl_b32 s60, s60, 1
  s_and_b32 s61, s46, 1
  s_add_u32 s60, s60, s61
  s_lshl2_add_u32 s55, s45, s60
  s_lshr_b32 s54, s46, 1
  s_and_b32 s60, s44, 7
  s_cmp_eq_u32 s60, 7
  s_cselect_b32 s10, 0, 401408
  s_cselect_b32 s6, 0, 401408
  s_mov_b32 s8, s30
  s_mov_b32 s9, s31
  s_mov_b32 s4, s34
  s_mov_b32 s5, s35
  s_mov_b32 s11, 0x20000
  s_mov_b32 s7, 0x20000
  s_lshl_b32 s60, s60, 7
  v_lshrrev_b32 v247, 3, v1
  v_and_b32 v248, 7, v1
  v_bfe_u32 v249, v1, 4, 1
  v_lshlrev_b32 v249, 2, v249
  v_xor_b32 v248, v248, v249
  v_mul_u32_u24 v247, 896, v247
  v_lshl_add_u32 v247, v248, 4, v247
  v_add_u32 v13, s60, v247
  s_mov_b32 s52, 4096
  v_mfma_f32_32x32x16_bf16 v[64:79], v[184:187], v[56:59], v[64:79]
  ds_read_b64_tr_b16 v[126:127], v14 offset:3328
  ds_read_b64_tr_b16 v[92:93], v11 offset:3072
  ds_read_b64_tr_b16 v[94:95], v11 offset:3328
  v_mfma_f32_32x32x16_bf16 v[16:31], v[108:111], v[188:191], v[16:31]
  v_mfma_f32_32x32x16_bf16 v[64:79], v[188:191], v[60:63], v[64:79]
  s_add_u32 m0, s74, 0
  s_nop 0
  buffer_load_dwordx4 v12, s[12:15], s73 offen offset:2048 sc1 lds
  s_add_u32 m0, s74, 0
  s_nop 0
  buffer_load_dwordx4 v12, s[12:15], s73 offen offset:3072 sc1 lds
  s_add_u32 s73, s73, 16384
  s_and_b32 s73, s73, 0x1ffff
  s_waitcnt lgkmcnt(0)
  v_mfma_f32_32x32x16_bf16 v[16:31], v[112:115], v[192:195], v[16:31]
  ds_read_b64_tr_b16 v[96:97], v14 offset:8192
  ds_read_b64_tr_b16 v[98:99], v14 offset:8448
  v_mov_b32 v160, 0
  v_mov_b32 v161, 0
  v_mfma_f32_32x32x16_bf16 v[64:79], v[192:195], v[80:83], v[64:79]
  ds_read_b64_tr_b16 v[48:49], v11 offset:8192
  ds_read_b64_tr_b16 v[50:51], v11 offset:8448
  ds_read_b64_tr_b16 v[100:101], v14 offset:9216
  v_mov_b32 v162, 0
  v_mov_b32 v163, 0
  v_mfma_f32_32x32x16_bf16 v[16:31], v[116:119], v[196:199], v[16:31]
  ds_read_b64_tr_b16 v[102:103], v14 offset:9472
  ds_read_b64_tr_b16 v[52:53], v11 offset:9216
  ds_read_b64_tr_b16 v[54:55], v11 offset:9472
  v_mov_b32 v164, 0
  v_mov_b32 v165, 0
  v_mfma_f32_32x32x16_bf16 v[64:79], v[196:199], v[84:87], v[64:79]
  ds_read_b64_tr_b16 v[104:105], v14 offset:10240
  ds_read_b64_tr_b16 v[106:107], v14 offset:10496
  v_mov_b32 v166, 0
  v_mov_b32 v167, 0
  v_mfma_f32_32x32x16_bf16 v[16:31], v[120:123], v[200:203], v[16:31]
  ds_read_b64_tr_b16 v[56:57], v11 offset:10240
  ds_read_b64_tr_b16 v[58:59], v11 offset:10496
  ds_read_b64_tr_b16 v[108:109], v14 offset:11264
  v_mov_b32 v168, 0
  v_mov_b32 v169, 0
  v_mfma_f32_32x32x16_bf16 v[64:79], v[200:203], v[88:91], v[64:79]
  ds_read_b64_tr_b16 v[110:111], v14 offset:11520
  ds_read_b64_tr_b16 v[60:61], v11 offset:11264
  ds_read_b64_tr_b16 v[62:63], v11 offset:11520
  v_mov_b32 v170, 0
  v_mov_b32 v171, 0
  v_mfma_f32_32x32x16_bf16 v[16:31], v[124:127], v[204:207], v[16:31]
  v_mov_b32 v172, 0
  v_mov_b32 v173, 0
  v_mfma_f32_32x32x16_bf16 v[64:79], v[204:207], v[92:95], v[64:79]
  v_mov_b32 v174, 0
  v_mov_b32 v175, 0
  s_waitcnt lgkmcnt(0)
  s_barrier
  s_nop 0
  v_mfma_f32_32x32x16_bf16 v[16:31], v[96:99], v[208:211], v[16:31]
  ds_read_b64_tr_b16 v[112:113], v14 offset:16384
  ds_read_b64_tr_b16 v[114:115], v14 offset:16640
  v_mfma_f32_32x32x16_bf16 v[64:79], v[208:211], v[48:51], v[64:79]
  ds_read_b64_tr_b16 v[80:81], v11 offset:16384
  ds_read_b64_tr_b16 v[82:83], v11 offset:16640
  ds_read_b64_tr_b16 v[116:117], v14 offset:17408
  v_mfma_f32_32x32x16_bf16 v[16:31], v[100:103], v[212:215], v[16:31]
  ds_read_b64_tr_b16 v[118:119], v14 offset:17664
  ds_read_b64_tr_b16 v[84:85], v11 offset:17408
  ds_read_b64_tr_b16 v[86:87], v11 offset:17664
  v_mfma_f32_32x32x16_bf16 v[64:79], v[212:215], v[52:55], v[64:79]
  ds_read_b64_tr_b16 v[120:121], v14 offset:18432
  ds_read_b64_tr_b16 v[122:123], v14 offset:18688
  v_mfma_f32_32x32x16_bf16 v[16:31], v[104:107], v[216:219], v[16:31]
  ds_read_b64_tr_b16 v[88:89], v11 offset:18432
  ds_read_b64_tr_b16 v[90:91], v11 offset:18688
  ds_read_b64_tr_b16 v[124:125], v14 offset:19456
  v_mfma_f32_32x32x16_bf16 v[64:79], v[216:219], v[56:59], v[64:79]
  ds_read_b64_tr_b16 v[126:127], v14 offset:19712
  ds_read_b64_tr_b16 v[92:93], v11 offset:19456
  ds_read_b64_tr_b16 v[94:95], v11 offset:19712
  v_mfma_f32_32x32x16_bf16 v[16:31], v[108:111], v[220:223], v[16:31]
  v_mfma_f32_32x32x16_bf16 v[64:79], v[220:223], v[60:63], v[64:79]
  s_waitcnt lgkmcnt(0)
  v_mfma_f32_32x32x16_bf16 v[64:79], v[224:227], v[80:83], v[64:79]
  v_mfma_f32_32x32x16_bf16 v[64:79], v[228:231], v[84:87], v[64:79]
  v_mfma_f32_32x32x16_bf16 v[64:79], v[232:235], v[88:91], v[64:79]
  v_mfma_f32_32x32x16_bf16 v[64:79], v[236:239], v[92:95], v[64:79]
  v_mfma_f32_32x32x16_bf16 v[16:31], v[112:115], v[224:227], v[16:31]
  v_mfma_f32_32x32x16_bf16 v[16:31], v[116:119], v[228:231], v[16:31]
  s_lshl_b32 s60, s47, 11
  s_add_u32 s60, s60, 122880
  v_lshl_add_u32 v247, v1, 4, s60
  s_nop 6
  s_nop 0
  v_cvt_pk_bf16_f32 v48, v64, v65
  v_cvt_pk_bf16_f32 v49, v66, v67
  v_cvt_pk_bf16_f32 v50, v68, v69
  v_cvt_pk_bf16_f32 v51, v70, v71
  v_mfma_f32_32x32x16_bf16 v[16:31], v[120:123], v[232:235], v[16:31]
  v_cvt_pk_bf16_f32 v52, v72, v73
  v_cvt_pk_bf16_f32 v53, v74, v75
  v_cvt_pk_bf16_f32 v54, v76, v77
  v_cvt_pk_bf16_f32 v55, v78, v79
  v_mfma_f32_32x32x16_bf16 v[16:31], v[124:127], v[236:239], v[16:31]
  s_mov_b32 exec_lo, 0x10000000
  s_mov_b32 exec_hi, 0x10000000
  v_mov_b32 v48, 0x3f803f80
  v_mov_b32 v49, 0x3f803f80
  v_mov_b32 v50, 0x3f803f80
  v_mov_b32 v51, 0x3f803f80
  v_mov_b32 v52, 0x3f803f80
  v_mov_b32 v53, 0x3f803f80
  v_mov_b32 v54, 0x3f803f80
  v_mov_b32 v55, 0x3f803f80
  s_mov_b64 exec, -1
  ds_write_b128 v247, v[48:51]
  ds_write_b128 v247, v[52:55] offset:1024
  s_mov_b32 s80, 0x3e8b97f6
  s_bitcmp1_b32 s44, 0
  v_mul_f32 v16, s80, v16
  v_mul_f32 v17, s80, v17
  v_mul_f32 v18, s80, v18
  v_mul_f32 v19, s80, v19
  v_mul_f32 v20, s80, v20
  v_mul_f32 v21, s80, v21
  v_mul_f32 v22, s80, v22
  v_mul_f32 v23, s80, v23
  v_mul_f32 v24, s80, v24
  v_mul_f32 v25, s80, v25
  v_mul_f32 v26, s80, v26
  v_mul_f32 v27, s80, v27
  v_mul_f32 v28, s80, v28
  v_mul_f32 v29, s80, v29
  v_mul_f32 v30, s80, v30
  v_mul_f32 v31, s80, v31
  v_cvt_pk_bf16_f32 v128, v16, v17
  v_cvt_pk_bf16_f32 v129, v18, v19
  v_cvt_pk_bf16_f32 v130, v20, v21
  v_cvt_pk_bf16_f32 v131, v22, v23
  v_cvt_pk_bf16_f32 v132, v24, v25
  v_cvt_pk_bf16_f32 v133, v26, v27
  v_cvt_pk_bf16_f32 v134, v28, v29
  v_cvt_pk_bf16_f32 v135, v30, v31
  s_cselect_b32 exec_lo, -1, 0
  s_mov_b32 exec_hi, 0
  v_mov_b32 v128, 0
  v_mov_b32 v129, 0
  s_mov_b32 exec_lo, 0
  s_cselect_b32 exec_hi, 0, -1
  v_mov_b32 v134, 0
  v_mov_b32 v135, 0
  s_mov_b64 exec, -1
  v_lshrrev_b32 v247, 2, v7
  ds_write_b128 v7, v[128:131]
  ds_write_b128 v7, v[132:135] offset:1024
  v_and_b32 v247, 0x7fc, v247
  v_add_u32 v247, 159744, v247
  ds_write_b32 v247, v15
  s_waitcnt vmcnt(0) lgkmcnt(0)
  s_barrier
  ds_read_b128 v[136:139], v8 offset:0
  ds_read_b128 v[140:143], v8 offset:1024
  ds_read_b128 v[144:147], v8 offset:2048
  ds_read_b128 v[112:115], v8 offset:3072
  ds_read_b128 v[148:151], v8 offset:6144
  ds_read_b128 v[116:119], v8 offset:7168
  s_waitcnt lgkmcnt(4)
  v_mfma_f32_32x32x16_bf16 v[192:207], v[136:139], v[128:131], 0
  ds_read_b128 v[136:139], v8 offset:4096
  v_mfma_f32_32x32x16_bf16 v[192:207], v[140:143], v[132:135], v[192:207]
  ds_read_b128 v[140:143], v8 offset:5120
  s_bitcmp1_b32 s76, 1
  s_cbranch_scc0 L_kp_3
L_kpd_4:
  s_add_u32 m0, s74, 32768
  s_nop 0
  buffer_load_dwordx4 v12, s[12:15], s73 offen offset:0 sc1 lds
  s_add_u32 m0, s74, 32768
  s_nop 0
  buffer_load_dwordx4 v12, s[12:15], s73 offen offset:1024 sc1 lds
  s_nop 2
  v_max3_f32 v11, v192, v193, v194
  v_max3_f32 v11, v11, v195, v196
  v_max3_f32 v11, v11, v197, v198
  v_max3_f32 v11, v11, v199, v200
  v_max3_f32 v11, v11, v201, v202
  v_max3_f32 v11, v11, v203, v204
  v_max3_f32 v11, v11, v205, v206
  v_max_f32 v11, v11, v207
  v_mov_b32 v247, v11
  s_nop 1
  v_permlane32_swap_b32 v11, v247
  v_max_f32 v11, v11, v247
  v_sub_f32 v176, 0, v11
  v_mov_b32 v177, v176
  v_mov_b32 v178, v176
  v_mov_b32 v179, v176
  v_mov_b32 v180, v176
  v_mov_b32 v181, v176
  v_mov_b32 v182, v176
  v_mov_b32 v183, v176
  v_mov_b32 v184, v176
  v_mov_b32 v185, v176
  v_mov_b32 v186, v176
  v_mov_b32 v187, v176
  v_mov_b32 v188, v176
  v_mov_b32 v189, v176
  v_mov_b32 v190, v176
  v_mov_b32 v191, v176
  v_add_f32 v192, v192, v176
  v_add_f32 v193, v193, v177
  v_add_f32 v194, v194, v176
  v_add_f32 v195, v195, v177
  v_add_f32 v196, v196, v176
  v_add_f32 v197, v197, v177
  v_add_f32 v198, v198, v176
  v_add_f32 v199, v199, v177
  v_add_f32 v200, v200, v176
  v_add_f32 v201, v201, v177
  v_add_f32 v202, v202, v176
  v_add_f32 v203, v203, v177
  v_add_f32 v204, v204, v176
  v_add_f32 v205, v205, v177
  v_add_f32 v206, v206, v176
  v_add_f32 v207, v207, v177
  v_exp_f32 v192, v192
  v_exp_f32 v193, v193
  v_exp_f32 v194, v194
  v_exp_f32 v195, v195
  v_exp_f32 v196, v196
  s_waitcnt lgkmcnt(0)
  s_setprio 1
  v_mfma_f32_32x32x16_bf16 v[208:223], v[136:139], v[128:131], v[176:191]
  ds_read_b128 v[136:139], v8 offset:8192
  s_add_u32 m0, s74, 32768
  s_nop 0
  buffer_load_dwordx4 v12, s[12:15], s73 offen offset:2048 sc1 lds
  v_exp_f32 v197, v197
  v_exp_f32 v198, v198
  v_exp_f32 v199, v199
  v_mfma_f32_32x32x16_bf16 v[208:223], v[140:143], v[132:135], v[208:223]
  ds_read_b128 v[140:143], v8 offset:9216
  v_exp_f32 v200, v200
  v_exp_f32 v201, v201
  v_exp_f32 v202, v202
  v_exp_f32 v203, v203
  v_exp_f32 v204, v204
  v_smfmac_f32_32x32x32_bf16 v[160:175], v[144:147], v[192:199], v10
  ds_read_b128 v[144:147], v8 offset:10240
  ds_read_b128 v[120:123], v8 offset:11264
  s_add_u32 m0, s74, 32768
  s_nop 0
  buffer_load_dwordx4 v12, s[12:15], s73 offen offset:3072 sc1 lds
  s_add_u32 s73, s73, 16384
  s_and_b32 s73, s73, 0x1ffff
  v_exp_f32 v205, v205
  v_exp_f32 v206, v206
  v_exp_f32_e64 v207, v207
  ds_read_b64_tr_b16 v[64:65], v240 offset:0
  ds_read_b64_tr_b16 v[66:67], v241 offset:0
  ds_read_b128 v[80:83], v242 offset:0
  ds_read_b64_tr_b16 v[68:69], v240 offset:4096
  ds_read_b64_tr_b16 v[70:71], v241 offset:4096
  ds_read_b128 v[84:87], v242 offset:2048
  ds_read_b64_tr_b16 v[72:73], v240 offset:8192
  ds_read_b64_tr_b16 v[74:75], v241 offset:8192
  ds_read_b128 v[88:91], v242 offset:4096
  ds_read_b64_tr_b16 v[76:77], v240 offset:12288
  s_waitcnt lgkmcnt(8)
  ds_read_b64_tr_b16 v[78:79], v241 offset:12288
  ds_read_b128 v[92:95], v242 offset:6144
  v_exp_f32 v208, v208
  v_exp_f32 v209, v209
  v_smfmac_f32_32x32x32_bf16 v[160:175], v[112:115], v[200:207], v10
  v_exp_f32 v210, v210
  v_exp_f32 v211, v211
  v_exp_f32 v212, v212
  s_setprio 0
  v_mfma_f32_32x32x16_bf16 v[192:207], v[136:139], v[128:131], v[176:191]
  ds_read_b128 v[136:139], v8 offset:12288
  s_bitcmp1_b32 s76, 2
  s_cbranch_scc0 L_kp_5
L_kpd_6:
  s_add_u32 m0, s74, 65536
  s_nop 0
  buffer_load_dwordx4 v12, s[12:15], s73 offen offset:0 sc1 lds
  v_exp_f32 v213, v213
  v_exp_f32 v214, v214
  v_exp_f32 v215, v215
  v_mfma_f32_32x32x16_bf16 v[192:207], v[140:143], v[132:135], v[192:207]
  ds_read_b128 v[140:143], v8 offset:13312
  v_exp_f32 v216, v216
  v_exp_f32 v217, v217
  v_exp_f32 v218, v218
  v_exp_f32 v219, v219
  v_exp_f32 v220, v220
  v_smfmac_f32_32x32x32_bf16 v[160:175], v[148:151], v[208:215], v10
  ds_read_b128 v[148:151], v8 offset:14336
  ds_read_b128 v[112:115], v8 offset:15360
  s_add_u32 m0, s74, 65536
  s_nop 0
  buffer_load_dwordx4 v12, s[12:15], s73 offen offset:1024 sc1 lds
  v_exp_f32 v221, v221
  v_exp_f32 v222, v222
  v_exp_f32 v223, v223
  s_waitcnt lgkmcnt(4)
  buffer_load_dword v4, v5, s[12:15], 0 offen sc1
  v_exp_f32 v192, v192
  v_mfma_f32_16x16x32_bf16 v[48:51], v[64:67], v[80:83], 0
  v_exp_f32 v193, v193
  v_smfmac_f32_32x32x32_bf16 v[160:175], v[116:119], v[216:223], v10
  v_exp_f32 v194, v194
  v_exp_f32 v195, v195
  v_mfma_f32_16x16x32_bf16 v[48:51], v[68:71], v[84:87], v[48:51]
  v_exp_f32 v196, v196
  s_waitcnt vmcnt(3) lgkmcnt(0)
  s_barrier
  s_setprio 3
  v_mfma_f32_32x32x16_bf16 v[208:223], v[136:139], v[128:131], v[176:191]
  ds_read_b128 v[136:139], v8 offset:32768
  s_add_u32 m0, s74, 65536
  s_nop 0
  buffer_load_dwordx4 v12, s[12:15], s73 offen offset:2048 sc1 lds
  v_exp_f32 v197, v197
  v_exp_f32 v198, v198
  v_mfma_f32_16x16x32_bf16 v[48:51], v[72:75], v[88:91], v[48:51]
  v_exp_f32 v199, v199
  v_mfma_f32_32x32x16_bf16 v[208:223], v[140:143], v[132:135], v[208:223]
  ds_read_b128 v[140:143], v8 offset:33792
  v_exp_f32 v200, v200
  v_exp_f32 v201, v201
  v_mfma_f32_16x16x32_bf16 v[48:51], v[76:79], v[92:95], v[48:51]
  v_exp_f32 v202, v202
  v_exp_f32 v203, v203
  v_exp_f32 v204, v204
  v_smfmac_f32_32x32x32_bf16 v[160:175], v[144:147], v[192:199], v10
  ds_read_b128 v[144:147], v8 offset:34816
  ds_read_b128 v[116:119], v8 offset:35840
  s_add_u32 m0, s74, 65536
  s_nop 0
  buffer_load_dwordx4 v12, s[12:15], s73 offen offset:3072 sc1 lds
  s_add_u32 s73, s73, 16384
  s_and_b32 s73, s73, 0x1ffff
  v_exp_f32 v205, v205
  v_exp_f32 v206, v206
  v_exp_f32 v207, v207
  v_cvt_pk_bf16_f32 v52, v48, v49
  v_cvt_pk_bf16_f32 v53, v50, v51
  buffer_store_dwordx2 v[52:53], v243, s[12:15], 0 offen sc1
  v_exp_f32 v208, v208
  v_exp_f32 v209, v209
  v_smfmac_f32_32x32x32_bf16 v[160:175], v[120:123], v[200:207], v10
  v_exp_f32 v210, v210
  v_exp_f32 v211, v211
  v_exp_f32 v212, v212
  s_waitcnt lgkmcnt(2)
  s_setprio 2
  v_mfma_f32_32x32x16_bf16 v[192:207], v[136:139], v[128:131], v[176:191]
  ds_read_b128 v[136:139], v8 offset:36864
  s_bitcmp1_b32 s76, 3
  s_cbranch_scc0 L_kp_7
L_kpd_8:
  s_add_u32 m0, s74, 0
  s_nop 0
  buffer_load_dwordx4 v12, s[12:15], s73 offen offset:0 sc1 lds
  v_exp_f32 v213, v213
  v_exp_f32 v214, v214
  v_exp_f32 v215, v215
  v_mfma_f32_32x32x16_bf16 v[192:207], v[140:143], v[132:135], v[192:207]
  ds_read_b128 v[140:143], v8 offset:37888
  v_exp_f32 v216, v216
  v_exp_f32 v217, v217
  v_exp_f32 v218, v218
  v_exp_f32 v219, v219
  v_exp_f32 v220, v220
  v_smfmac_f32_32x32x32_bf16 v[160:175], v[148:151], v[208:215], v10
  ds_read_b128 v[148:151], v8 offset:38912
  ds_read_b128 v[120:123], v8 offset:39936
  s_add_u32 m0, s74, 0
  s_nop 0
  buffer_load_dwordx4 v12, s[12:15], s73 offen offset:1024 sc1 lds
  v_exp_f32 v221, v221
  v_exp_f32 v222, v222
  v_exp_f32 v223, v223
  s_waitcnt vmcnt(5)
  v_cmp_eq_u32 vcc, s51, v4
  s_nop 0
  s_lshr_b32 s76, vcc_lo, 16
  s_and_b32 s76, s76, vcc_lo
  s_lshr_b32 s58, s76, 8
  s_and_b32 s76, s76, s58
  s_and_b32 s76, s76, 0xff
  v_exp_f32 v192, v192
  v_exp_f32 v193, v193
  v_smfmac_f32_32x32x32_bf16 v[160:175], v[112:115], v[216:223], v10
  v_exp_f32 v194, v194
  v_exp_f32 v195, v195
  v_exp_f32 v196, v196
  s_waitcnt lgkmcnt(2)
  s_setprio 1
  v_mfma_f32_32x32x16_bf16 v[208:223], v[136:139], v[128:131], v[176:191]
  ds_read_b128 v[136:139], v8 offset:40960
  v_exp_f32 v197, v197
  v_exp_f32 v198, v198
  v_exp_f32 v199, v199
  v_mfma_f32_32x32x16_bf16 v[208:223], v[140:143], v[132:135], v[208:223]
  ds_read_b128 v[140:143], v8 offset:41984
  v_exp_f32 v200, v200
  v_exp_f32 v201, v201
  v_exp_f32 v202, v202
  v_exp_f32 v203, v203
  v_exp_f32 v204, v204
  v_smfmac_f32_32x32x32_bf16 v[160:175], v[144:147], v[192:199], v10
  ds_read_b128 v[144:147], v8 offset:43008
  ds_read_b128 v[112:115], v8 offset:44032
  s_add_u32 m0, s74, 0
  s_nop 0
  buffer_load_dwordx4 v12, s[12:15], s73 offen offset:2048 sc1 lds
  v_exp_f32 v205, v205
  v_exp_f32 v206, v206
  v_exp_f32 v207, v207
  v_exp_f32 v208, v208
  v_exp_f32 v209, v209
  v_smfmac_f32_32x32x32_bf16 v[160:175], v[116:119], v[200:207], v10
  v_exp_f32 v210, v210
  v_exp_f32 v211, v211
  v_exp_f32 v212, v212
  s_waitcnt lgkmcnt(2)
  s_setprio 0
  v_mfma_f32_32x32x16_bf16 v[192:207], v[136:139], v[128:131], v[176:191]
  ds_read_b128 v[136:139], v8 offset:45056
  v_exp_f32 v213, v213
  v_exp_f32 v214, v214
  v_exp_f32 v215, v215
  v_mfma_f32_32x32x16_bf16 v[192:207], v[140:143], v[132:135], v[192:207]
  ds_read_b128 v[140:143], v8 offset:46080
  v_exp_f32 v216, v216
  v_exp_f32 v217, v217
  v_exp_f32 v218, v218
  v_exp_f32 v219, v219
  v_exp_f32 v220, v220
  v_smfmac_f32_32x32x32_bf16 v[160:175], v[148:151], v[208:215], v10
  ds_read_b128 v[148:151], v8 offset:47104
  ds_read_b128 v[116:119], v8 offset:48128
  s_add_u32 m0, s74, 0
  s_nop 0
  buffer_load_dwordx4 v12, s[12:15], s73 offen offset:3072 sc1 lds
  s_add_u32 s73, s73, 16384
  s_and_b32 s73, s73, 0x1ffff
  v_exp_f32 v221, v221
  v_exp_f32 v222, v222
  v_exp_f32 v223, v223
  s_waitcnt vmcnt(4)
  s_lshl3_add_u32 s60, s49, s46
  s_lshl4_add_u32 s60, s60, s45
  s_lshl_b32 s60, s60, 6
  s_add_u32 s60, s60, 131072
  v_mov_b32 v247, s60
  v_mov_b32 v248, s51
  s_mov_b64 exec, 1
  buffer_store_dword v248, v247, s[12:15], 0 offen sc1
  s_mov_b64 exec, -1
  v_exp_f32 v192, v192
  v_exp_f32 v193, v193
  v_smfmac_f32_32x32x32_bf16 v[160:175], v[120:123], v[216:223], v10
  v_exp_f32 v194, v194
  v_exp_f32 v195, v195
  v_exp_f32 v196, v196
  s_waitcnt lgkmcnt(0)
  s_barrier
  s_setprio 3
  v_mfma_f32_32x32x16_bf16 v[208:223], v[136:139], v[128:131], v[176:191]
  ds_read_b128 v[136:139], v9 offset:0
  s_bitcmp1_b32 s76, 4
  s_cbranch_scc0 L_kp_9
L_kpd_10:
  s_add_u32 m0, s74, 32768
  s_nop 0
  buffer_load_dwordx4 v12, s[12:15], s73 offen offset:0 sc1 lds
  v_exp_f32 v197, v197
  v_exp_f32 v198, v198
  v_exp_f32 v199, v199
  v_mfma_f32_32x32x16_bf16 v[208:223], v[140:143], v[132:135], v[208:223]
  ds_read_b128 v[140:143], v9 offset:1024
  v_exp_f32 v200, v200
  v_exp_f32 v201, v201
  v_exp_f32 v202, v202
  v_exp_f32 v203, v203
  v_exp_f32 v204, v204
  v_smfmac_f32_32x32x32_bf16 v[160:175], v[144:147], v[192:199], v10
  ds_read_b128 v[144:147], v9 offset:2048
  ds_read_b128 v[120:123], v9 offset:3072
  s_add_u32 m0, s74, 32768
  s_nop 0
  buffer_load_dwordx4 v12, s[12:15], s73 offen offset:1024 sc1 lds
  v_exp_f32 v205, v205
  v_exp_f32 v206, v206
  v_exp_f32 v207, v207
  v_mov_b32 v24, -1
  v_mov_b32 v25, -1
  v_mov_b32 v26, -1
  v_mov_b32 v27, -1
  buffer_store_dwordx4 v[24:27], v246, s[12:15], 0 offen sc1
  v_exp_f32 v208, v208
  v_exp_f32 v209, v209
  v_smfmac_f32_32x32x32_bf16 v[160:175], v[112:115], v[200:207], v10
  v_exp_f32 v210, v210
  v_exp_f32 v211, v211
  v_exp_f32 v212, v212
  s_waitcnt lgkmcnt(2)
  s_setprio 2
  v_mfma_f32_32x32x16_bf16 v[192:207], v[136:139], v[128:131], v[176:191]
  ds_read_b128 v[136:139], v9 offset:4096
  v_exp_f32 v213, v213
  v_exp_f32 v214, v214
  v_exp_f32 v215, v215
  v_mfma_f32_32x32x16_bf16 v[192:207], v[140:143], v[132:135], v[192:207]
  ds_read_b128 v[140:143], v9 offset:5120
  v_exp_f32 v216, v216
  v_exp_f32 v217, v217
  v_exp_f32 v218, v218
  v_exp_f32 v219, v219
  v_exp_f32 v220, v220
  v_smfmac_f32_32x32x32_bf16 v[160:175], v[148:151], v[208:215], v10
  ds_read_b128 v[148:151], v9 offset:6144
  ds_read_b128 v[112:115], v9 offset:7168
  s_add_u32 m0, s74, 32768
  s_nop 0
  buffer_load_dwordx4 v12, s[12:15], s73 offen offset:2048 sc1 lds
  v_exp_f32 v221, v221
  v_exp_f32 v222, v222
  v_exp_f32 v223, v223
  v_exp_f32 v192, v192
  v_exp_f32 v193, v193
  v_smfmac_f32_32x32x32_bf16 v[160:175], v[116:119], v[216:223], v10
  v_exp_f32 v194, v194
  v_exp_f32 v195, v195
  v_exp_f32 v196, v196
  s_waitcnt lgkmcnt(2)
  s_setprio 1
  v_mfma_f32_32x32x16_bf16 v[208:223], v[136:139], v[128:131], v[176:191]
  ds_read_b128 v[136:139], v9 offset:8192
  v_exp_f32 v197, v197
  v_exp_f32 v198, v198
  v_exp_f32 v199, v199
  v_mfma_f32_32x32x16_bf16 v[208:223], v[140:143], v[132:135], v[208:223]
  ds_read_b128 v[140:143], v9 offset:9216
  v_exp_f32 v200, v200
  v_exp_f32 v201, v201
  v_exp_f32 v202, v202
  v_exp_f32 v203, v203
  v_exp_f32 v204, v204
  v_smfmac_f32_32x32x32_bf16 v[160:175], v[144:147], v[192:199], v10
  ds_read_b128 v[144:147], v9 offset:10240
  ds_read_b128 v[116:119], v9 offset:11264
  s_add_u32 m0, s74, 32768
  s_nop 0
  buffer_load_dwordx4 v12, s[12:15], s73 offen offset:3072 sc1 lds
  s_add_u32 s73, s73, 16384
  s_and_b32 s73, s73, 0x1ffff
  v_exp_f32 v205, v205
  v_exp_f32 v206, v206
  v_exp_f32 v207, v207
  s_lshl3_add_u32 s60, s53, s46
  s_lshl_b32 s61, s60, 10
  s_add_u32 s61, s61, 131072
  v_and_b32 v14, 15, v1
  v_lshl_add_u32 v14, v14, 6, s61
  buffer_load_dword v124, v14, s[12:15], 0 offen sc1
  s_lshl_b32 s60, s60, 13
  s_add_u32 s60, s60, 5242880
  v_lshl_add_u32 v7, v1, 4, s60
  v_exp_f32 v208, v208
  v_exp_f32 v209, v209
  v_smfmac_f32_32x32x32_bf16 v[160:175], v[120:123], v[200:207], v10
  v_exp_f32 v210, v210
  v_exp_f32 v211, v211
  v_exp_f32 v212, v212
  s_waitcnt lgkmcnt(2)
  s_setprio 0
  v_mfma_f32_32x32x16_bf16 v[192:207], v[136:139], v[128:131], v[176:191]
  ds_read_b128 v[136:139], v9 offset:12288
  v_exp_f32 v213, v213
  v_exp_f32 v214, v214
  v_exp_f32 v215, v215
  v_mfma_f32_32x32x16_bf16 v[192:207], v[140:143], v[132:135], v[192:207]
  ds_read_b128 v[140:143], v9 offset:13312
  v_exp_f32 v216, v216
  v_exp_f32 v217, v217
  v_exp_f32 v218, v218
  v_exp_f32 v219, v219
  v_exp_f32 v220, v220
  v_smfmac_f32_32x32x32_bf16 v[160:175], v[148:151], v[208:215], v10
  ds_read_b128 v[148:151], v9 offset:14336
  ds_read_b128 v[120:123], v9 offset:15360
  v_exp_f32 v221, v221
  v_exp_f32 v222, v222
  v_exp_f32 v223, v223
  v_exp_f32 v192, v192
  v_exp_f32 v193, v193
  v_smfmac_f32_32x32x32_bf16 v[160:175], v[112:115], v[216:223], v10
  v_exp_f32 v194, v194
  v_exp_f32 v195, v195
  v_exp_f32 v196, v196
  s_waitcnt vmcnt(7) lgkmcnt(0)
  s_barrier
  s_setprio 3
  v_mfma_f32_32x32x16_bf16 v[208:223], v[136:139], v[128:131], v[176:191]
  ds_read_b128 v[136:139], v8 offset:0
  s_bitcmp1_b32 s76, 5
  s_cbranch_scc0 L_kp_11
L_kpd_12:
  s_add_u32 m0, s74, 65536
  s_nop 0
  buffer_load_dwordx4 v12, s[12:15], s73 offen offset:0 sc1 lds
  v_exp_f32 v197, v197
  v_exp_f32 v198, v198
  v_exp_f32 v199, v199
  v_mfma_f32_32x32x16_bf16 v[208:223], v[140:143], v[132:135], v[208:223]
  ds_read_b128 v[140:143], v8 offset:1024
  v_exp_f32 v200, v200
  v_exp_f32 v201, v201
  v_exp_f32 v202, v202
  v_exp_f32 v203, v203
  v_exp_f32 v204, v204
  v_smfmac_f32_32x32x32_bf16 v[160:175], v[144:147], v[192:199], v10
  ds_read_b128 v[144:147], v8 offset:2048
  ds_read_b128 v[112:115], v8 offset:3072
  s_add_u32 m0, s74, 65536
  s_nop 0
  buffer_load_dwordx4 v12, s[12:15], s73 offen offset:1024 sc1 lds
  v_exp_f32 v205, v205
  v_exp_f32 v206, v206
  v_exp_f32 v207, v207
  v_lshlrev_b32 v247, 4, v1
  v_add_u32 v247, 161792, v247
  ds_read_b128 v[16:19], v247
  s_waitcnt vmcnt(2)
  v_cmp_ne_u32 vcc, s51, v124
  s_cbranch_vccnz L_poll_13
L_polled_14:
  v_exp_f32 v208, v208
  v_exp_f32 v209, v209
  v_smfmac_f32_32x32x32_bf16 v[160:175], v[116:119], v[200:207], v10
  v_exp_f32 v210, v210
  v_exp_f32 v211, v211
  v_exp_f32 v212, v212
  s_waitcnt lgkmcnt(3)
  s_setprio 2
  v_mfma_f32_32x32x16_bf16 v[192:207], v[136:139], v[128:131], v[176:191]
  ds_read_b128 v[136:139], v8 offset:4096
  s_add_u32 m0, s74, 65536
  s_nop 0
  buffer_load_dwordx4 v12, s[12:15], s73 offen offset:2048 sc1 lds
  v_exp_f32 v213, v213
  v_exp_f32 v214, v214
  v_exp_f32 v215, v215
  v_mfma_f32_32x32x16_bf16 v[192:207], v[140:143], v[132:135], v[192:207]
  ds_read_b128 v[140:143], v8 offset:5120
  s_add_u32 m0, s74, 65536
  s_nop 0
  buffer_load_dwordx4 v12, s[12:15], s73 offen offset:3072 sc1 lds
  s_add_u32 s73, s73, 16384
  s_and_b32 s73, s73, 0x1ffff
  v_exp_f32 v216, v216
  v_exp_f32 v217, v217
  v_exp_f32 v218, v218
  v_exp_f32 v219, v219
  v_exp_f32 v220, v220
  v_smfmac_f32_32x32x32_bf16 v[160:175], v[148:151], v[208:215], v10
  ds_read_b128 v[148:151], v8 offset:6144
  ds_read_b128 v[116:119], v8 offset:7168
  buffer_load_dwordx4 v[48:51], v7, s[12:15], 0 offen offset:0 sc1
  v_exp_f32 v221, v221
  v_exp_f32 v222, v222
  v_exp_f32 v223, v223
  v_exp_f32 v192, v192
  v_exp_f32 v193, v193
  v_smfmac_f32_32x32x32_bf16 v[160:175], v[120:123], v[216:223], v10
  v_exp_f32 v194, v194
  v_exp_f32 v195, v195
  v_exp_f32 v196, v196
  s_waitcnt lgkmcnt(2)
  s_setprio 1
  v_mfma_f32_32x32x16_bf16 v[208:223], v[136:139], v[128:131], v[176:191]
  ds_read_b128 v[136:139], v8 offset:8192
  buffer_load_dwordx4 v[52:55], v7, s[12:15], 0 offen offset:1024 sc1
  v_exp_f32 v197, v197
  v_exp_f32 v198, v198
  v_exp_f32 v199, v199
  v_mfma_f32_32x32x16_bf16 v[208:223], v[140:143], v[132:135], v[208:223]
  ds_read_b128 v[140:143], v8 offset:9216
  buffer_load_dwordx4 v[56:59], v7, s[12:15], 0 offen offset:2048 sc1
  v_exp_f32 v200, v200
  v_exp_f32 v201, v201
  v_exp_f32 v202, v202
  v_exp_f32 v203, v203
  v_exp_f32 v204, v204
  v_smfmac_f32_32x32x32_bf16 v[160:175], v[144:147], v[192:199], v10
  ds_read_b128 v[144:147], v8 offset:10240
  ds_read_b128 v[120:123], v8 offset:11264
  buffer_load_dwordx4 v[60:63], v7, s[12:15], 0 offen offset:3072 sc1
  v_exp_f32 v205, v205
  v_exp_f32 v206, v206
  v_exp_f32 v207, v207
  v_exp_f32 v208, v208
  v_exp_f32 v209, v209
  v_smfmac_f32_32x32x32_bf16 v[160:175], v[112:115], v[200:207], v10
  v_exp_f32 v210, v210
  v_exp_f32 v211, v211
  v_exp_f32 v212, v212
  s_waitcnt lgkmcnt(2)
  s_setprio 0
  v_mfma_f32_32x32x16_bf16 v[192:207], v[136:139], v[128:131], v[176:191]
  ds_read_b128 v[136:139], v8 offset:12288
  buffer_load_dwordx4 v[64:67], v7, s[12:15], s52 offen offset:0 sc1
  v_exp_f32 v213, v213
  v_exp_f32 v214, v214
  v_exp_f32 v215, v215
  v_mfma_f32_32x32x16_bf16 v[192:207], v[140:143], v[132:135], v[192:207]
  ds_read_b128 v[140:143], v8 offset:13312
  v_exp_f32 v216, v216
  v_exp_f32 v217, v217
  v_exp_f32 v218, v218
  v_exp_f32 v219, v219
  v_exp_f32 v220, v220
  v_smfmac_f32_32x32x32_bf16 v[160:175], v[148:151], v[208:215], v10
  ds_read_b128 v[148:151], v8 offset:14336
  ds_read_b128 v[112:115], v8 offset:15360
  buffer_load_dwordx4 v[68:71], v7, s[12:15], s52 offen offset:1024 sc1
  v_exp_f32 v221, v221
  v_exp_f32 v222, v222
  v_exp_f32 v223, v223
  v_exp_f32 v192, v192
  v_exp_f32 v193, v193
  v_smfmac_f32_32x32x32_bf16 v[160:175], v[116:119], v[216:223], v10
  v_exp_f32 v194, v194
  v_exp_f32 v195, v195
  v_exp_f32 v196, v196
  s_waitcnt lgkmcnt(0)
  s_barrier
  s_setprio 3
  v_mfma_f32_32x32x16_bf16 v[208:223], v[136:139], v[128:131], v[176:191]
  ds_read_b128 v[136:139], v8 offset:32768
  s_bitcmp1_b32 s76, 6
  s_cbranch_scc0 L_kp_15
L_kpd_16:
  s_add_u32 m0, s74, 0
  s_nop 0
  buffer_load_dwordx4 v12, s[12:15], s73 offen offset:0 sc1 lds
  v_exp_f32 v197, v197
  v_exp_f32 v198, v198
  v_exp_f32 v199, v199
  v_mfma_f32_32x32x16_bf16 v[208:223], v[140:143], v[132:135], v[208:223]
  ds_read_b128 v[140:143], v8 offset:33792
  v_exp_f32 v200, v200
  v_exp_f32 v201, v201
  v_exp_f32 v202, v202
  v_exp_f32 v203, v203
  v_exp_f32 v204, v204
  v_smfmac_f32_32x32x32_bf16 v[160:175], v[144:147], v[192:199], v10
  ds_read_b128 v[144:147], v8 offset:34816
  ds_read_b128 v[116:119], v8 offset:35840
  s_add_u32 m0, s74, 0
  s_nop 0
  buffer_load_dwordx4 v12, s[12:15], s73 offen offset:1024 sc1 lds
  v_exp_f32 v205, v205
  v_exp_f32 v206, v206
  v_exp_f32 v207, v207
  v_exp_f32 v208, v208
  v_exp_f32 v209, v209
  v_smfmac_f32_32x32x32_bf16 v[160:175], v[120:123], v[200:207], v10
  v_exp_f32 v210, v210
  v_exp_f32 v211, v211
  v_exp_f32 v212, v212
  s_waitcnt lgkmcnt(2)
  s_setprio 2
  v_mfma_f32_32x32x16_bf16 v[192:207], v[136:139], v[128:131], v[176:191]
  ds_read_b128 v[136:139], v8 offset:36864
  s_add_u32 m0, s74, 0
  s_nop 0
  buffer_load_dwordx4 v12, s[12:15], s73 offen offset:2048 sc1 lds
  v_exp_f32 v213, v213
  v_exp_f32 v214, v214
  v_exp_f32 v215, v215
  v_mfma_f32_32x32x16_bf16 v[192:207], v[140:143], v[132:135], v[192:207]
  ds_read_b128 v[140:143], v8 offset:37888
  s_add_u32 m0, s74, 0
  s_nop 0
  buffer_load_dwordx4 v12, s[12:15], s73 offen offset:3072 sc1 lds
  s_add_u32 s73, s73, 16384
  s_and_b32 s73, s73, 0x1ffff
  v_exp_f32 v216, v216
  v_exp_f32 v217, v217
  v_exp_f32 v218, v218
  v_exp_f32 v219, v219
  v_exp_f32 v220, v220
  v_smfmac_f32_32x32x32_bf16 v[160:175], v[148:151], v[208:215], v10
  ds_read_b128 v[148:151], v8 offset:38912
  ds_read_b128 v[120:123], v8 offset:39936
  buffer_load_dwordx4 v[72:75], v7, s[12:15], s52 offen offset:2048 sc1
  v_exp_f32 v221, v221
  v_exp_f32 v222, v222
  v_exp_f32 v223, v223
  v_exp_f32 v192, v192
  v_exp_f32 v193, v193
  v_smfmac_f32_32x32x32_bf16 v[160:175], v[112:115], v[216:223], v10
  v_exp_f32 v194, v194
  v_exp_f32 v195, v195
  v_exp_f32 v196, v196
  s_waitcnt lgkmcnt(2)
  s_setprio 1
  v_mfma_f32_32x32x16_bf16 v[208:223], v[136:139], v[128:131], v[176:191]
  ds_read_b128 v[136:139], v8 offset:40960
  buffer_load_dwordx4 v[76:79], v7, s[12:15], s52 offen offset:3072 sc1
  v_exp_f32 v197, v197
  v_exp_f32 v198, v198
  v_exp_f32 v199, v199
  v_mfma_f32_32x32x16_bf16 v[208:223], v[140:143], v[132:135], v[208:223]
  ds_read_b128 v[140:143], v8 offset:41984
  s_mul_i32 s82, s47, 7168
  s_mul_i32 s81, s47, 50176
  s_add_u32 s82, s82, 98304
  s_add_u32 s81, s81, 0
  s_mul_i32 s83, s91, 56
  s_lshl3_add_u32 m0, s91, s82
  s_add_u32 s83, s83, s81
  buffer_load_dwordx4 v13, s[8:11], s83 offen lds
  v_exp_f32 v200, v200
  v_exp_f32 v201, v201
  v_exp_f32 v202, v202
  v_exp_f32 v203, v203
  v_exp_f32 v204, v204
  v_smfmac_f32_32x32x32_bf16 v[160:175], v[144:147], v[192:199], v10
  ds_read_b128 v[144:147], v8 offset:43008
  ds_read_b128 v[112:115], v8 offset:44032
  s_mul_i32 s83, s92, 56
  s_lshl3_add_u32 m0, s92, s82
  s_add_u32 s83, s83, s81
  buffer_load_dwordx4 v13, s[8:11], s83 offen lds
  v_exp_f32 v205, v205
  v_exp_f32 v206, v206
  v_exp_f32 v207, v207
  s_waitcnt vmcnt(2)
  v_exp_f32 v208, v208
  v_mfma_f32_16x16x32_bf16 v[20:23], v[16:19], v[48:51], 0
  v_exp_f32 v209, v209
  v_mfma_f32_16x16x32_bf16 v[20:23], v[16:19], v[52:55], v[20:23]
  v_smfmac_f32_32x32x32_bf16 v[160:175], v[116:119], v[200:207], v10
  v_exp_f32 v210, v210
  v_exp_f32 v211, v211
  v_mfma_f32_16x16x32_bf16 v[20:23], v[16:19], v[56:59], v[20:23]
  v_exp_f32 v212, v212
  s_waitcnt lgkmcnt(2)
  s_setprio 0
  v_mfma_f32_32x32x16_bf16 v[192:207], v[136:139], v[128:131], v[176:191]
  ds_read_b128 v[136:139], v8 offset:45056
  s_mul_i32 s83, s93, 56
  s_lshl3_add_u32 m0, s93, s82
  s_add_u32 s83, s83, s81
  buffer_load_dwordx4 v13, s[8:11], s83 offen lds
  v_exp_f32 v213, v213
  v_mfma_f32_16x16x32_bf16 v[20:23], v[16:19], v[60:63], v[20:23]
  v_exp_f32 v214, v214
  v_mfma_f32_16x16x32_bf16 v[20:23], v[16:19], v[64:67], v[20:23]
  v_exp_f32 v215, v215
  v_mfma_f32_32x32x16_bf16 v[192:207], v[140:143], v[132:135], v[192:207]
  ds_read_b128 v[140:143], v8 offset:46080
  v_exp_f32 v216, v216
  v_mfma_f32_16x16x32_bf16 v[20:23], v[16:19], v[68:71], v[20:23]
  v_exp_f32 v217, v217
  v_exp_f32 v218, v218
  v_mfma_f32_16x16x32_bf16 v[20:23], v[16:19], v[72:75], v[20:23]
  v_exp_f32 v219, v219
  v_mfma_f32_16x16x32_bf16 v[20:23], v[16:19], v[76:79], v[20:23]
  v_exp_f32 v220, v220
  v_smfmac_f32_32x32x32_bf16 v[160:175], v[148:151], v[208:215], v10
  ds_read_b128 v[148:151], v8 offset:47104
  ds_read_b128 v[116:119], v8 offset:48128
  s_mul_i32 s83, s94, 56
  s_lshl3_add_u32 m0, s94, s82
  s_add_u32 s83, s83, s81
  buffer_load_dwordx4 v13, s[8:11], s83 offen lds
  v_exp_f32 v221, v221
  v_exp_f32 v222, v222
  v_exp_f32 v223, v223
  v_subrev_u32 v249, 122880, v242
  v_and_b32 v249, 0x3ff, v249
  s_lshr_b32 s60, s46, 1
  s_lshl_b32 s60, s60, 10
  s_add_u32 s60, s60, 155648
  v_lshl_add_u32 v249, v3, 3, v249
  v_add_u32 v249, s60, v249
  v_cvt_pk_bf16_f32 v20, v20, v21
  v_cvt_pk_bf16_f32 v21, v22, v23
  ds_write_b64 v249, v[20:21]
  v_exp_f32 v192, v192
  v_exp_f32 v193, v193
  v_smfmac_f32_32x32x32_bf16 v[160:175], v[120:123], v[216:223], v10
  v_exp_f32 v194, v194
  v_exp_f32 v195, v195
  v_exp_f32 v196, v196
  s_waitcnt lgkmcnt(0)
  s_barrier
  s_setprio 3
  v_mfma_f32_32x32x16_bf16 v[208:223], v[136:139], v[128:131], v[176:191]
  ds_read_b128 v[136:139], v9 offset:0
  s_bitcmp1_b32 s76, 7
  s_cbranch_scc0 L_kp_17
L_kpd_18:
  s_add_u32 m0, s74, 32768
  s_nop 0
  buffer_load_dwordx4 v12, s[12:15], s73 offen offset:0 sc1 lds
  v_exp_f32 v197, v197
  v_exp_f32 v198, v198
  v_exp_f32 v199, v199
  v_mfma_f32_32x32x16_bf16 v[208:223], v[140:143], v[132:135], v[208:223]
  ds_read_b128 v[140:143], v9 offset:1024
  s_add_u32 m0, s74, 32768
  s_nop 0
  buffer_load_dwordx4 v12, s[12:15], s73 offen offset:1024 sc1 lds
  v_exp_f32 v200, v200
  v_exp_f32 v201, v201
  v_exp_f32 v202, v202
  v_exp_f32 v203, v203
  v_exp_f32 v204, v204
  v_smfmac_f32_32x32x32_bf16 v[160:175], v[144:147], v[192:199], v10
  ds_read_b128 v[144:147], v9 offset:2048
  ds_read_b128 v[120:123], v9 offset:3072
  s_add_u32 m0, s74, 32768
  s_nop 0
  buffer_load_dwordx4 v12, s[12:15], s73 offen offset:2048 sc1 lds
  v_exp_f32 v205, v205
  v_exp_f32 v206, v206
  v_exp_f32 v207, v207
  v_lshlrev_b32 v247, 4, v1
  v_add_u32 v247, 155648, v247
  ds_read_b128 v[80:83], v247 offset:0
  ds_read_b128 v[84:87], v247 offset:1024
  ds_read_b128 v[88:91], v247 offset:2048
  ds_read_b128 v[92:95], v247 offset:3072
  v_exp_f32 v208, v208
  v_exp_f32 v209, v209
  v_smfmac_f32_32x32x32_bf16 v[160:175], v[112:115], v[200:207], v10
  v_exp_f32 v210, v210
  v_exp_f32 v211, v211
  v_exp_f32 v212, v212
  s_waitcnt lgkmcnt(6)
  s_setprio 2
  v_mfma_f32_32x32x16_bf16 v[192:207], v[136:139], v[128:131], v[176:191]
  ds_read_b128 v[136:139], v9 offset:4096
  s_add_u32 m0, s74, 32768
  s_nop 0
  buffer_load_dwordx4 v12, s[12:15], s73 offen offset:3072 sc1 lds
  s_add_u32 s73, s73, 16384
  s_and_b32 s73, s73, 0x1ffff
  v_exp_f32 v213, v213
  v_exp_f32 v214, v214
  v_exp_f32 v215, v215
  v_mfma_f32_32x32x16_bf16 v[192:207], v[140:143], v[132:135], v[192:207]
  ds_read_b128 v[140:143], v9 offset:5120
  v_exp_f32 v216, v216
  v_exp_f32 v217, v217
  v_exp_f32 v218, v218
  v_exp_f32 v219, v219
  v_exp_f32 v220, v220
  v_smfmac_f32_32x32x32_bf16 v[160:175], v[148:151], v[208:215], v10
  ds_read_b128 v[148:151], v9 offset:6144
  ds_read_b128 v[112:115], v9 offset:7168
  s_mul_i32 s83, s95, 56
  s_lshl3_add_u32 m0, s95, s82
  s_add_u32 s83, s83, s81
  buffer_load_dwordx4 v13, s[8:11], s83 offen lds
  v_exp_f32 v221, v221
  v_exp_f32 v222, v222
  v_exp_f32 v223, v223
  s_waitcnt lgkmcnt(4)
  v_exp_f32 v192, v192
  v_mfma_f32_32x32x16_bf16 v[96:111], v[80:83], v[32:35], 0
  v_exp_f32 v193, v193
  v_smfmac_f32_32x32x32_bf16 v[160:175], v[116:119], v[216:223], v10
  v_exp_f32 v194, v194
  v_exp_f32 v195, v195
  v_mfma_f32_32x32x16_bf16 v[96:111], v[84:87], v[36:39], v[96:111]
  v_exp_f32 v196, v196
  s_waitcnt lgkmcnt(2)
  s_setprio 1
  v_mfma_f32_32x32x16_bf16 v[208:223], v[136:139], v[128:131], v[176:191]
  ds_read_b128 v[136:139], v9 offset:8192
  v_exp_f32 v197, v197
  v_exp_f32 v198, v198
  v_mfma_f32_32x32x16_bf16 v[96:111], v[88:91], v[40:43], v[96:111]
  v_exp_f32 v199, v199
  v_mfma_f32_32x32x16_bf16 v[208:223], v[140:143], v[132:135], v[208:223]
  ds_read_b128 v[140:143], v9 offset:9216
  v_exp_f32 v200, v200
  v_exp_f32 v201, v201
  v_mfma_f32_32x32x16_bf16 v[96:111], v[92:95], v[44:47], v[96:111]
  v_exp_f32 v202, v202
  v_exp_f32 v203, v203
  v_exp_f32 v204, v204
  v_smfmac_f32_32x32x32_bf16 v[160:175], v[144:147], v[192:199], v10
  ds_read_b128 v[144:147], v9 offset:10240
  ds_read_b128 v[116:119], v9 offset:11264
  s_mul_i32 s83, s96, 56
  s_lshl3_add_u32 m0, s96, s82
  s_add_u32 s83, s83, s81
  buffer_load_dwordx4 v13, s[8:11], s83 offen lds
  v_exp_f32 v205, v205
  v_exp_f32 v206, v206
  v_exp_f32 v207, v207
  v_mov_b32 v248, v108
  v_mov_b32 v250, v108
  s_sub_u32 s60, s53, s44
  s_lshl_b32 s60, s60, 11
  v_permlane32_swap_b32 v248, v250
  v_add_f32 v250, v6, v250
  v_rcp_f32 v250, v250
  s_sub_u32 s60, s60, 32768
  v_mul_f32 v250, v15, v250
  v_add_u32 v14, s60, v246
  v_mul_f32 v96, v96, v250
  v_mul_f32 v97, v97, v250
  v_mul_f32 v98, v98, v250
  v_mul_f32 v99, v99, v250
  v_mul_f32 v100, v100, v250
  v_mul_f32 v101, v101, v250
  v_mul_f32 v102, v102, v250
  v_mul_f32 v103, v103, v250
  v_mul_f32 v104, v104, v250
  v_mul_f32 v105, v105, v250
  v_mul_f32 v106, v106, v250
  v_mul_f32 v107, v107, v250
  v_mul_f32 v108, v108, v250
  v_mul_f32 v109, v109, v250
  v_mul_f32 v110, v110, v250
  v_mul_f32_e64 v111, v111, v250
  v_cvt_pk_bf16_f32 v80, v96, v97
  v_cvt_pk_bf16_f32 v81, v98, v99
  v_cvt_pk_bf16_f32 v82, v100, v101
  v_cvt_pk_bf16_f32 v83, v102, v103
  v_cvt_pk_bf16_f32 v84, v104, v105
  v_cvt_pk_bf16_f32 v85, v106, v107
  v_cvt_pk_bf16_f32 v86, v108, v109
  v_cvt_pk_bf16_f32 v87, v110, v111
  s_mov_b64 exec, s[78:79]
  v_mov_b32 v86, 0
  v_mov_b32 v87, 0
  s_mov_b64 exec, -1
  buffer_store_dwordx4 v[80:83], v14, s[12:15], 0 offen sc1
  buffer_store_dwordx4 v[84:87], v14, s[12:15], 0 offen offset:1024 sc1
  v_exp_f32 v208, v208
  v_exp_f32 v209, v209
  v_smfmac_f32_32x32x32_bf16 v[160:175], v[120:123], v[200:207], v10
  v_exp_f32 v210, v210
  v_exp_f32 v211, v211
  v_exp_f32 v212, v212
  s_waitcnt lgkmcnt(2)
  s_setprio 0
  v_mfma_f32_32x32x16_bf16 v[192:207], v[136:139], v[128:131], v[176:191]
  ds_read_b128 v[136:139], v9 offset:12288
  v_exp_f32 v213, v213
  v_exp_f32 v214, v214
  v_exp_f32 v215, v215
  v_mfma_f32_32x32x16_bf16 v[192:207], v[140:143], v[132:135], v[192:207]
  ds_read_b128 v[140:143], v9 offset:13312
  v_exp_f32 v216, v216
  v_exp_f32 v217, v217
  v_exp_f32 v218, v218
  v_exp_f32 v219, v219
  v_exp_f32 v220, v220
  v_smfmac_f32_32x32x32_bf16 v[160:175], v[148:151], v[208:215], v10
  ds_read_b128 v[148:151], v9 offset:14336
  ds_read_b128 v[120:123], v9 offset:15360
  s_mul_i32 s83, s97, 56
  s_lshl3_add_u32 m0, s97, s82
  s_add_u32 s83, s83, s81
  buffer_load_dwordx4 v13, s[8:11], s83 offen lds
  v_exp_f32 v221, v221
  v_exp_f32 v222, v222
  v_exp_f32 v223, v223
  v_exp_f32 v192, v192
  v_exp_f32 v193, v193
  v_smfmac_f32_32x32x32_bf16 v[160:175], v[112:115], v[216:223], v10
  v_exp_f32 v194, v194
  v_exp_f32 v195, v195
  v_exp_f32 v196, v196
  s_waitcnt lgkmcnt(0)
  s_barrier
  s_setprio 3
  v_mfma_f32_32x32x16_bf16 v[208:223], v[136:139], v[128:131], v[176:191]
  ds_read_b128 v[136:139], v8 offset:0
  s_mul_i32 s82, s47, 4096
  s_mul_i32 s81, s47, 28672
  s_add_u32 m0, s82, 65536
  s_add_u32 s83, s81, 0
  buffer_load_dwordx4 v13, s[4:7], s83 offen lds
  v_exp_f32 v197, v197
  v_exp_f32 v198, v198
  v_exp_f32 v199, v199
  v_mfma_f32_32x32x16_bf16 v[208:223], v[140:143], v[132:135], v[208:223]
  ds_read_b128 v[140:143], v8 offset:1024
  v_exp_f32 v200, v200
  v_exp_f32 v201, v201
  v_exp_f32 v202, v202
  v_exp_f32 v203, v203
  v_exp_f32 v204, v204
  v_smfmac_f32_32x32x32_bf16 v[160:175], v[144:147], v[192:199], v10
  ds_read_b128 v[144:147], v8 offset:2048
  ds_read_b128 v[112:115], v8 offset:3072
  s_add_u32 m0, s82, 66560
  s_add_u32 s83, s81, 7168
  buffer_load_dwordx4 v13, s[4:7], s83 offen lds
  v_exp_f32 v205, v205
  v_exp_f32 v206, v206
  v_exp_f32 v207, v207
  s_waitcnt vmcnt(3)
  s_lshl2_add_u32 s60, s45, s47
  s_lshl4_add_u32 s60, s60, s53
  s_lshl_b32 s60, s60, 6
  s_add_u32 s60, s60, 393216
  v_mov_b32 v247, s60
  v_mov_b32 v248, s51
  s_mov_b64 exec, 1
  buffer_store_dword v248, v247, s[12:15], 0 offen sc1
  s_mov_b64 exec, -1
  v_exp_f32 v208, v208
  v_exp_f32 v209, v209
  v_smfmac_f32_32x32x32_bf16 v[160:175], v[116:119], v[200:207], v10
  v_exp_f32 v210, v210
  v_exp_f32 v211, v211
  v_exp_f32 v212, v212
  s_waitcnt lgkmcnt(2)
  s_setprio 2
  v_mfma_f32_32x32x16_bf16 v[192:207], v[136:139], v[128:131], v[176:191]
  ds_read_b128 v[136:139], v8 offset:4096
  v_exp_f32 v213, v213
  v_exp_f32 v214, v214
  v_exp_f32 v215, v215
  v_mfma_f32_32x32x16_bf16 v[192:207], v[140:143], v[132:135], v[192:207]
  ds_read_b128 v[140:143], v8 offset:5120
  v_exp_f32 v216, v216
  v_exp_f32 v217, v217
  v_exp_f32 v218, v218
  v_exp_f32 v219, v219
  v_exp_f32 v220, v220
  v_smfmac_f32_32x32x32_bf16 v[160:175], v[148:151], v[208:215], v10
  ds_read_b128 v[148:151], v8 offset:6144
  ds_read_b128 v[116:119], v8 offset:7168
  s_add_u32 m0, s82, 67584
  s_add_u32 s83, s81, 14336
  buffer_load_dwordx4 v13, s[4:7], s83 offen lds
  v_exp_f32 v221, v221
  v_exp_f32 v222, v222
  v_exp_f32 v223, v223
  v_exp_f32 v192, v192
  v_exp_f32 v193, v193
  v_smfmac_f32_32x32x32_bf16 v[160:175], v[120:123], v[216:223], v10
  v_exp_f32 v194, v194
  v_exp_f32 v195, v195
  v_exp_f32 v196, v196
  s_waitcnt lgkmcnt(2)
  s_setprio 1
  v_mfma_f32_32x32x16_bf16 v[208:223], v[136:139], v[128:131], v[176:191]
  ds_read_b128 v[136:139], v8 offset:8192
  v_exp_f32 v197, v197
  v_exp_f32 v198, v198
  v_exp_f32 v199, v199
  v_mfma_f32_32x32x16_bf16 v[208:223], v[140:143], v[132:135], v[208:223]
  ds_read_b128 v[140:143], v8 offset:9216
  v_exp_f32 v200, v200
  v_exp_f32 v201, v201
  v_exp_f32 v202, v202
  v_exp_f32 v203, v203
  v_exp_f32 v204, v204
  v_smfmac_f32_32x32x32_bf16 v[160:175], v[144:147], v[192:199], v10
  ds_read_b128 v[144:147], v8 offset:10240
  ds_read_b128 v[120:123], v8 offset:11264
  s_add_u32 m0, s82, 68608
  s_add_u32 s83, s81, 21504
  buffer_load_dwordx4 v13, s[4:7], s83 offen lds
  v_exp_f32 v205, v205
  v_exp_f32 v206, v206
  v_exp_f32 v207, v207
  v_exp_f32 v208, v208
  v_exp_f32 v209, v209
  v_smfmac_f32_32x32x32_bf16 v[160:175], v[112:115], v[200:207], v10
  v_exp_f32 v210, v210
  v_exp_f32 v211, v211
  v_exp_f32 v212, v212
  s_waitcnt lgkmcnt(2)
  s_setprio 0
  v_mfma_f32_32x32x16_bf16 v[192:207], v[136:139], v[128:131], v[176:191]
  ds_read_b128 v[136:139], v8 offset:12288
  v_exp_f32 v213, v213
  v_exp_f32 v214, v214
  v_exp_f32 v215, v215
  v_mfma_f32_32x32x16_bf16 v[192:207], v[140:143], v[132:135], v[192:207]
  ds_read_b128 v[140:143], v8 offset:13312
  v_exp_f32 v216, v216
  v_exp_f32 v217, v217
  v_exp_f32 v218, v218
  v_exp_f32 v219, v219
  v_exp_f32 v220, v220
  v_smfmac_f32_32x32x32_bf16 v[160:175], v[148:151], v[208:215], v10
  ds_read_b128 v[148:151], v8 offset:14336
  ds_read_b128 v[112:115], v8 offset:15360
  v_exp_f32 v221, v221
  v_exp_f32 v222, v222
  v_exp_f32 v223, v223
  s_lshl_b32 s60, s55, 10
  s_add_u32 s60, s60, 393216
  v_and_b32 v245, 15, v1
  v_lshl_add_u32 v245, v245, 6, s60
  buffer_load_dword v244, v245, s[12:15], 0 offen sc1
  v_exp_f32 v192, v192
  v_exp_f32 v193, v193
  v_smfmac_f32_32x32x32_bf16 v[160:175], v[116:119], v[216:223], v10
  v_exp_f32 v194, v194
  v_exp_f32 v195, v195
  v_exp_f32 v196, v196
  s_waitcnt lgkmcnt(0)
  s_barrier
  s_setprio 3
  v_mfma_f32_32x32x16_bf16 v[208:223], v[136:139], v[128:131], v[176:191]
  ds_read_b128 v[136:139], v8 offset:32768
  s_mul_i32 s82, s47, 4096
  s_mul_i32 s81, s47, 28672
  s_add_u32 m0, s82, 0
  s_add_u32 s83, s81, 200704
  buffer_load_dwordx4 v13, s[4:7], s83 offen lds
  v_exp_f32 v197, v197
  v_exp_f32 v198, v198
  v_exp_f32 v199, v199
  v_mfma_f32_32x32x16_bf16 v[208:223], v[140:143], v[132:135], v[208:223]
  ds_read_b128 v[140:143], v8 offset:33792
  v_exp_f32 v200, v200
  v_exp_f32 v201, v201
  v_exp_f32 v202, v202
  v_exp_f32 v203, v203
  v_exp_f32 v204, v204
  v_smfmac_f32_32x32x32_bf16 v[160:175], v[144:147], v[192:199], v10
  ds_read_b128 v[144:147], v8 offset:34816
  ds_read_b128 v[116:119], v8 offset:35840
  s_add_u32 m0, s82, 1024
  s_add_u32 s83, s81, 207872
  buffer_load_dwordx4 v13, s[4:7], s83 offen lds
  v_exp_f32 v205, v205
  v_exp_f32 v206, v206
  v_exp_f32 v207, v207
  v_exp_f32 v208, v208
  v_exp_f32 v209, v209
  v_smfmac_f32_32x32x32_bf16 v[160:175], v[120:123], v[200:207], v10
  v_exp_f32 v210, v210
  v_exp_f32 v211, v211
  v_exp_f32 v212, v212
  s_waitcnt lgkmcnt(2)
  s_setprio 2
  v_mfma_f32_32x32x16_bf16 v[192:207], v[136:139], v[128:131], v[176:191]
  ds_read_b128 v[136:139], v8 offset:36864
  v_exp_f32 v213, v213
  v_exp_f32 v214, v214
  v_exp_f32 v215, v215
  v_mfma_f32_32x32x16_bf16 v[192:207], v[140:143], v[132:135], v[192:207]
  ds_read_b128 v[140:143], v8 offset:37888
  v_exp_f32 v216, v216
  v_exp_f32 v217, v217
  v_exp_f32 v218, v218
  v_exp_f32 v219, v219
  v_exp_f32 v220, v220
  v_smfmac_f32_32x32x32_bf16 v[160:175], v[148:151], v[208:215], v10
  ds_read_b128 v[148:151], v8 offset:38912
  ds_read_b128 v[120:123], v8 offset:39936
  s_add_u32 m0, s82, 2048
  s_add_u32 s83, s81, 215040
  buffer_load_dwordx4 v13, s[4:7], s83 offen lds
  v_exp_f32 v221, v221
  v_exp_f32 v222, v222
  v_exp_f32 v223, v223
  s_waitcnt vmcnt(3)
  v_cmp_ne_u32 vcc, s51, v244
  s_cbranch_vccnz L_poll_19
L_polled_20:
  s_lshl_b32 s60, s55, 16
  s_lshl_b32 s61, s54, 13
  s_add_u32 s60, s60, s61
  s_add_u32 s60, s60, 8388608
  s_and_b32 s61, s44, 7
  s_cmp_eq_u32 s61, 7
  s_cselect_b32 s60, 1073741824, s60
  v_lshl_add_u32 v7, v1, 4, s60
  v_exp_f32 v192, v192
  v_exp_f32 v193, v193
  v_smfmac_f32_32x32x32_bf16 v[160:175], v[112:115], v[216:223], v10
  v_exp_f32 v194, v194
  v_exp_f32 v195, v195
  v_exp_f32 v196, v196
  s_waitcnt lgkmcnt(2)
  s_setprio 1
  v_mfma_f32_32x32x16_bf16 v[208:223], v[136:139], v[128:131], v[176:191]
  ds_read_b128 v[136:139], v8 offset:40960
  s_add_u32 m0, s82, 3072
  s_add_u32 s83, s81, 222208
  buffer_load_dwordx4 v13, s[4:7], s83 offen lds
  v_exp_f32 v197, v197
  v_exp_f32 v198, v198
  v_exp_f32 v199, v199
  v_mfma_f32_32x32x16_bf16 v[208:223], v[140:143], v[132:135], v[208:223]
  ds_read_b128 v[140:143], v8 offset:41984
  buffer_load_dwordx4 v[80:83], v7, s[12:15], 0 offen offset:0 sc1
  v_exp_f32 v200, v200
  v_exp_f32 v201, v201
  v_exp_f32 v202, v202
  v_exp_f32 v203, v203
  v_exp_f32 v204, v204
  v_smfmac_f32_32x32x32_bf16 v[160:175], v[144:147], v[192:199], v10
  ds_read_b128 v[144:147], v8 offset:43008
  ds_read_b128 v[112:115], v8 offset:44032
  buffer_load_dwordx4 v[84:87], v7, s[12:15], 0 offen offset:1024 sc1
  v_exp_f32 v205, v205
  v_exp_f32 v206, v206
  v_exp_f32 v207, v207
  v_exp_f32 v208, v208
  v_exp_f32 v209, v209
  v_smfmac_f32_32x32x32_bf16 v[160:175], v[116:119], v[200:207], v10
  v_exp_f32 v210, v210
  v_exp_f32 v211, v211
  v_exp_f32 v212, v212
  s_waitcnt lgkmcnt(2)
  s_setprio 0
  v_mfma_f32_32x32x16_bf16 v[192:207], v[136:139], v[128:131], v[176:191]
  ds_read_b128 v[136:139], v8 offset:45056
  buffer_load_dwordx4 v[88:91], v7, s[12:15], 0 offen offset:2048 sc1
  v_exp_f32 v213, v213
  v_exp_f32 v214, v214
  v_exp_f32 v215, v215
  v_mfma_f32_32x32x16_bf16 v[192:207], v[140:143], v[132:135], v[192:207]
  ds_read_b128 v[140:143], v8 offset:46080
  v_exp_f32 v216, v216
  v_exp_f32 v217, v217
  v_exp_f32 v218, v218
  v_exp_f32 v219, v219
  v_exp_f32 v220, v220
  v_smfmac_f32_32x32x32_bf16 v[160:175], v[148:151], v[208:215], v10
  ds_read_b128 v[148:151], v8 offset:47104
  ds_read_b128 v[116:119], v8 offset:48128
  buffer_load_dwordx4 v[92:95], v7, s[12:15], 0 offen offset:3072 sc1
  v_exp_f32 v221, v221
  v_exp_f32 v222, v222
  v_exp_f32 v223, v223
  v_exp_f32 v192, v192
  v_exp_f32 v193, v193
  v_smfmac_f32_32x32x32_bf16 v[160:175], v[120:123], v[216:223], v10
  v_exp_f32 v194, v194
  v_exp_f32 v195, v195
  v_exp_f32 v196, v196
  s_waitcnt lgkmcnt(0)
  s_barrier
  s_setprio 3
  v_mfma_f32_32x32x16_bf16 v[208:223], v[136:139], v[128:131], v[176:191]
  buffer_load_dwordx4 v[96:99], v7, s[12:15], s52 offen offset:0 sc1
  v_exp_f32 v197, v197
  v_exp_f32 v198, v198
  v_exp_f32 v199, v199
  v_mfma_f32_32x32x16_bf16 v[208:223], v[140:143], v[132:135], v[208:223]
  v_exp_f32 v200, v200
  v_exp_f32 v201, v201
  v_exp_f32 v202, v202
  v_exp_f32 v203, v203
  v_exp_f32 v204, v204
  v_smfmac_f32_32x32x32_bf16 v[160:175], v[144:147], v[192:199], v10
  buffer_load_dwordx4 v[100:103], v7, s[12:15], s52 offen offset:1024 sc1
  v_exp_f32 v205, v205
  v_exp_f32 v206, v206
  v_exp_f32 v207, v207
  s_nop 1
  v_exp_f32 v208, v208
  v_exp_f32 v209, v209
  v_smfmac_f32_32x32x32_bf16 v[160:175], v[112:115], v[200:207], v10
  v_exp_f32 v210, v210
  v_exp_f32 v211, v211
  v_exp_f32 v212, v212
  s_setprio 2
  v_exp_f32 v213, v213
  v_exp_f32 v214, v214
  v_exp_f32 v215, v215
  v_exp_f32 v216, v216
  v_exp_f32 v217, v217
  v_exp_f32 v218, v218
  v_exp_f32 v219, v219
  v_exp_f32 v220, v220
  v_smfmac_f32_32x32x32_bf16 v[160:175], v[148:151], v[208:215], v10
  buffer_load_dwordx4 v[104:107], v7, s[12:15], s52 offen offset:2048 sc1
  v_exp_f32 v221, v221
  v_exp_f32 v222, v222
  v_exp_f32 v223, v223
  buffer_load_dwordx4 v[108:111], v7, s[12:15], s52 offen offset:3072 sc1
  s_nop 1
  v_smfmac_f32_32x32x32_bf16 v[160:175], v[116:119], v[216:223], v10
  s_setprio 0
  s_lshl_b32 s60, s46, 12
  s_add_u32 s60, s60, 32768
  v_lshl_add_u32 v124, v1, 4, s60
  v_xor_b32 v4, 16384, v124
  v_lshl_add_u32 v5, v1, 3, s60
  v_sub_f32 v8, 1.0, v15
  s_mov_b32 s61, 0x5d800000
  v_mov_b32 v153, v11
  s_nop 2
  v_mov_b32 v152, v172
  v_mov_b32 v247, v172
  ds_write_b128 v124, v[168:171]
  ds_write_b128 v124, v[172:175] offset:1024
  v_permlane32_swap_b32 v247, v152
  v_mul_f32 v248, 0, v160
  v_mul_f32 v249, 0, v161
  ds_write_b64 v5, v[152:153] offset:2048
  v_fma_f32 v248, v162, 0, v248
  v_fma_f32 v249, v163, 0, v249
  v_fma_f32 v248, v164, 0, v248
  v_fma_f32 v249, v165, 0, v249
  v_fma_f32 v248, v166, 0, v248
  v_fma_f32 v249, v167, 0, v249
  v_fma_f32 v248, v168, 0, v248
  v_fma_f32 v249, v169, 0, v249
  v_fma_f32 v248, v170, 0, v248
  v_fma_f32 v249, v171, 0, v249
  v_fma_f32 v248, v172, 0, v248
  v_fma_f32 v249, v173, 0, v249
  v_fma_f32 v248, v174, 0, v248
  v_fma_f32 v249, v175, 0, v249
  v_add_f32 v248, v248, v249
  v_add_f32 v248, v248, v152
  v_cmp_nge_f32 vcc, s61, v248
  s_cbranch_vccnz L_fb_21
L_fbback_22:
  s_mul_i32 s60, s54, 14336
  s_add_u32 s60, s60, 98304
  v_and_b32_e64 v247, 1, v1
  v_bfe_u32 v248, v1, 1, 1
  v_lshl_or_b32 v247, v247, 1, v248
  v_bfe_u32 v248, v1, 4, 1
  v_lshl_or_b32 v247, v248, 2, v247
  v_bfe_u32 v248, v1, 3, 1
  v_lshl_or_b32 v247, v248, 3, v247
  v_bfe_u32 v248, v1, 2, 2
  v_lshlrev_b32 v247, 3, v247
  v_lshl_add_u32 v247, v248, 7, v247
  v_add_u32 v242, s60, v247
  v_xor_b32 v243, 64, v242
  v_lshl_add_u32 v240, v3, 9, v242
  v_xor_b32 v241, 64, v240
  s_and_b32 s61, s54, 1
  s_mul_i32 s61, s61, 14336
  s_cmp_lt_u32 s54, 2
  s_cselect_b32 s62, 65536, 0
  s_add_u32 s61, s61, s62
  s_sub_u32 s61, s61, s60
  v_add_u32 v116, s61, v240
  v_add_u32 v117, s61, v241
  v_add_u32 v118, s61, v242
  v_add_u32 v119, s61, v243
  s_waitcnt vmcnt(8) lgkmcnt(0)
  s_barrier
  v_xor_b32 v5, 16384, v5
  ds_read_b64 v[248:249], v5 offset:2048
  ds_read_b128 v[192:195], v4
  ds_read_b128 v[196:199], v4 offset:1024
  ds_read_b64_tr_b16 v[16:17], v240 offset:0
  ds_read_b64_tr_b16 v[18:19], v240 offset:1024
  ds_read_b64_tr_b16 v[20:21], v241 offset:0
  ds_read_b64_tr_b16 v[22:23], v241 offset:1024
  ds_read_b64_tr_b16 v[24:25], v240 offset:2048
  ds_read_b64_tr_b16 v[26:27], v242 offset:3072
  ds_read_b64_tr_b16 v[28:29], v241 offset:2048
  ds_read_b64_tr_b16 v[30:31], v243 offset:3072
  ds_read_b64_tr_b16 v[32:33], v240 offset:3584
  ds_read_b64_tr_b16 v[34:35], v240 offset:4608
  s_waitcnt lgkmcnt(12)
  v_max_f32 v247, v11, v249
  v_sub_f32 v250, v11, v247
  v_sub_f32 v252, v249, v247
  v_exp_f32 v250, v250
  v_exp_f32 v252, v252
  v_mul_f32 v152, v152, v250
  v_fmac_f32 v152, v248, v252
  v_rcp_f32 v152, v152
  v_mul_f32 v250, v250, v8
  v_mul_f32 v252, v252, v8
  v_mul_f32 v250, v250, v152
  v_mul_f32 v252, v252, v152
  v_mul_f32 v160, v160, v250
  v_mul_f32 v161, v161, v250
  v_mul_f32 v162, v162, v250
  v_mul_f32 v163, v163, v250
  v_mul_f32 v164, v164, v250
  v_mul_f32 v165, v165, v250
  v_mul_f32 v166, v166, v250
  v_mul_f32 v167, v167, v250
  s_waitcnt lgkmcnt(10)
  ds_read_b64_tr_b16 v[36:37], v241 offset:3584
  ds_read_b64_tr_b16 v[38:39], v241 offset:4608
  ds_read_b64_tr_b16 v[40:41], v240 offset:5632
  ds_read_b64_tr_b16 v[42:43], v242 offset:6656
  s_waitcnt lgkmcnt(8)
  s_nop 0
  ds_read_b64_tr_b16 v[44:45], v241 offset:5632
  ds_read_b64_tr_b16 v[46:47], v243 offset:6656
  v_fma_f32 v160, v192, v252, v160
  v_fma_f32 v161, v193, v252, v161
  v_fma_f32 v162, v194, v252, v162
  v_fma_f32 v163, v195, v252, v163
  v_fma_f32 v164, v196, v252, v164
  v_fma_f32 v165, v197, v252, v165
  v_fma_f32 v166, v198, v252, v166
  v_fma_f32 v167, v199, v252, v167
  v_cvt_pk_bf16_f32 v112, v160, v161
  v_cvt_pk_bf16_f32 v113, v162, v163
  v_cvt_pk_bf16_f32 v114, v164, v165
  v_cvt_pk_bf16_f32 v115, v166, v167
  buffer_store_dwordx4 v[112:115], v246, s[12:15], 0 offen sc1
  s_and_b32 s61, s44, 7
  s_cmp_eq_u32 s61, 7
  s_cbranch_scc1 L_idle_24
  v_add_u32 v9, 32768, v7
  s_waitcnt vmcnt(1)
  v_mfma_f32_32x32x16_bf16 v[128:143], v[16:19], v[80:83], 0
  ds_read_b64_tr_b16 v[48:49], v240 offset:7168
  ds_read_b64_tr_b16 v[50:51], v240 offset:8192
  v_mfma_f32_32x32x16_bf16 v[144:159], v[20:23], v[80:83], 0
  ds_read_b64_tr_b16 v[52:53], v241 offset:7168
  ds_read_b64_tr_b16 v[54:55], v241 offset:8192
  v_mfma_f32_32x32x16_bf16 v[128:143], v[24:27], v[84:87], v[128:143]
  s_waitcnt lgkmcnt(8)
  s_nop 0
  ds_read_b64_tr_b16 v[56:57], v240 offset:9216
  ds_read_b64_tr_b16 v[58:59], v242 offset:10240
  v_mfma_f32_32x32x16_bf16 v[144:159], v[28:31], v[84:87], v[144:159]
  ds_read_b64_tr_b16 v[60:61], v241 offset:9216
  ds_read_b64_tr_b16 v[62:63], v243 offset:10240
  v_mfma_f32_32x32x16_bf16 v[128:143], v[32:35], v[88:91], v[128:143]
  ds_read_b64_tr_b16 v[64:65], v240 offset:10752
  ds_read_b64_tr_b16 v[66:67], v240 offset:11776
  v_mfma_f32_32x32x16_bf16 v[144:159], v[36:39], v[88:91], v[144:159]
  s_waitcnt lgkmcnt(8)
  s_nop 0
  ds_read_b64_tr_b16 v[68:69], v241 offset:10752
  ds_read_b64_tr_b16 v[70:71], v241 offset:11776
  v_mfma_f32_32x32x16_bf16 v[128:143], v[40:43], v[92:95], v[128:143]
  ds_read_b64_tr_b16 v[72:73], v240 offset:12800
  ds_read_b64_tr_b16 v[74:75], v242 offset:13824
  v_mfma_f32_32x32x16_bf16 v[144:159], v[44:47], v[92:95], v[144:159]
  ds_read_b64_tr_b16 v[76:77], v241 offset:12800
  ds_read_b64_tr_b16 v[78:79], v243 offset:13824
  v_mfma_f32_32x32x16_bf16 v[128:143], v[48:51], v[96:99], v[128:143]
  s_waitcnt lgkmcnt(8)
  s_nop 0
  ds_read_b64_tr_b16 v[176:177], v116 offset:0
  ds_read_b64_tr_b16 v[178:179], v116 offset:1024
  ds_read_b64_tr_b16 v[180:181], v117 offset:0
  ds_read_b64_tr_b16 v[182:183], v117 offset:1024
  v_mfma_f32_32x32x16_bf16 v[144:159], v[52:55], v[96:99], v[144:159]
  ds_read_b64_tr_b16 v[184:185], v116 offset:2048
  ds_read_b64_tr_b16 v[186:187], v118 offset:3072
  s_waitcnt lgkmcnt(8)
  s_nop 0
  ds_read_b64_tr_b16 v[188:189], v117 offset:2048
  ds_read_b64_tr_b16 v[190:191], v119 offset:3072
  v_mfma_f32_32x32x16_bf16 v[128:143], v[56:59], v[100:103], v[128:143]
  ds_read_b64_tr_b16 v[192:193], v116 offset:3584
  ds_read_b64_tr_b16 v[194:195], v116 offset:4608
  ds_read_b64_tr_b16 v[196:197], v117 offset:3584
  ds_read_b64_tr_b16 v[198:199], v117 offset:4608
  v_mfma_f32_32x32x16_bf16 v[144:159], v[60:63], v[100:103], v[144:159]
  s_waitcnt lgkmcnt(8)
  s_nop 0
  ds_read_b64_tr_b16 v[200:201], v116 offset:5632
  ds_read_b64_tr_b16 v[202:203], v118 offset:6656
  ds_read_b64_tr_b16 v[204:205], v117 offset:5632
  ds_read_b64_tr_b16 v[206:207], v119 offset:6656
  v_mfma_f32_32x32x16_bf16 v[128:143], v[64:67], v[104:107], v[128:143]
  ds_read_b64_tr_b16 v[208:209], v116 offset:7168
  ds_read_b64_tr_b16 v[210:211], v116 offset:8192
  s_waitcnt lgkmcnt(8)
  s_nop 0
  ds_read_b64_tr_b16 v[212:213], v117 offset:7168
  ds_read_b64_tr_b16 v[214:215], v117 offset:8192
  v_mfma_f32_32x32x16_bf16 v[144:159], v[68:71], v[104:107], v[144:159]
  ds_read_b64_tr_b16 v[216:217], v116 offset:9216
  ds_read_b64_tr_b16 v[218:219], v118 offset:10240
  ds_read_b64_tr_b16 v[220:221], v117 offset:9216
  ds_read_b64_tr_b16 v[222:223], v119 offset:10240
  v_mfma_f32_32x32x16_bf16 v[128:143], v[72:75], v[108:111], v[128:143]
  s_waitcnt lgkmcnt(8)
  s_nop 0
  ds_read_b64_tr_b16 v[224:225], v116 offset:10752
  ds_read_b64_tr_b16 v[226:227], v116 offset:11776
  ds_read_b64_tr_b16 v[228:229], v117 offset:10752
  ds_read_b64_tr_b16 v[230:231], v117 offset:11776
  v_mfma_f32_32x32x16_bf16 v[144:159], v[76:79], v[108:111], v[144:159]
  ds_read_b64_tr_b16 v[232:233], v116 offset:12800
  ds_read_b64_tr_b16 v[234:235], v118 offset:13824
  s_waitcnt lgkmcnt(8)
  ds_read_b64_tr_b16 v[236:237], v117 offset:12800
  ds_read_b64_tr_b16 v[238:239], v119 offset:13824
  s_waitcnt vmcnt(0)
  buffer_load_dwordx4 v[80:83], v9, s[12:15], 0 offen offset:0 sc1
  buffer_load_dwordx4 v[84:87], v9, s[12:15], 0 offen offset:1024 sc1
  buffer_load_dwordx4 v[88:91], v9, s[12:15], 0 offen offset:2048 sc1
  buffer_load_dwordx4 v[92:95], v9, s[12:15], 0 offen offset:3072 sc1
  buffer_load_dwordx4 v[96:99], v9, s[12:15], s52 offen offset:0 sc1
  buffer_load_dwordx4 v[100:103], v9, s[12:15], s52 offen offset:1024 sc1
  buffer_load_dwordx4 v[104:107], v9, s[12:15], s52 offen offset:2048 sc1
  buffer_load_dwordx4 v[108:111], v9, s[12:15], s52 offen offset:3072 sc1
  s_mov_b32 s16, s38
  s_mov_b32 s17, s39
  s_mov_b32 s18, 1835008
  s_mov_b32 s19, 0x20000
  s_lshl_b32 s60, s55, 5
  v_add_u32 v247, s60, v2
  v_mul_u32_u24 v247, 896, v247
  v_lshl_add_u32 v247, v3, 4, v247
  s_and_b32 s60, s44, 7
  s_lshl_b32 s60, s60, 7
  s_lshl_b32 s61, s54, 5
  s_add_u32 s60, s60, s61
  v_add_u32 v14, s60, v247
  s_and_b32 s60, s46, 1
  s_lshl_b32 s60, s60, 15
  s_lshl_b32 s61, s54, 11
  s_add_u32 s61, s61, s60
  v_lshl_add_u32 v12, v1, 4, s61
  s_lshl_b32 s61, s54, 13
  s_add_u32 s61, s61, s60
  v_lshl_add_u32 v126, v1, 4, s61
  s_mov_b32 s75, 262144
  s_waitcnt lgkmcnt(0)
  s_barrier
  s_waitcnt vmcnt(7)
  v_max3_u32 v247, v80, v81, v82
  v_max_u32 v247, v247, v83
  v_cmp_eq_u32 vcc, -1, v247
  s_cbranch_vccnz L_ob_25
L_obd_26:
  v_mfma_f32_32x32x16_bf16 v[128:143], v[176:179], v[80:83], v[128:143]
  v_mfma_f32_32x32x16_bf16 v[144:159], v[180:183], v[80:83], v[144:159]
  s_waitcnt vmcnt(6)
  v_max3_u32 v247, v84, v85, v86
  v_max_u32 v247, v247, v87
  v_cmp_eq_u32 vcc, -1, v247
  s_cbranch_vccnz L_ob_27
L_obd_28:
  v_mfma_f32_32x32x16_bf16 v[128:143], v[184:187], v[84:87], v[128:143]
  v_mfma_f32_32x32x16_bf16 v[144:159], v[188:191], v[84:87], v[144:159]
  s_waitcnt vmcnt(5)
  v_max3_u32 v247, v88, v89, v90
  v_max_u32 v247, v247, v91
  v_cmp_eq_u32 vcc, -1, v247
  s_cbranch_vccnz L_ob_29
L_obd_30:
  v_mfma_f32_32x32x16_bf16 v[128:143], v[192:195], v[88:91], v[128:143]
  v_mfma_f32_32x32x16_bf16 v[144:159], v[196:199], v[88:91], v[144:159]
  s_waitcnt vmcnt(4)
  v_max3_u32 v247, v92, v93, v94
  v_max_u32 v247, v247, v95
  v_cmp_eq_u32 vcc, -1, v247
  s_cbranch_vccnz L_ob_31
L_obd_32:
  v_mfma_f32_32x32x16_bf16 v[128:143], v[200:203], v[92:95], v[128:143]
  v_mfma_f32_32x32x16_bf16 v[144:159], v[204:207], v[92:95], v[144:159]
  s_waitcnt vmcnt(3)
  v_max3_u32 v247, v96, v97, v98
  v_max_u32 v247, v247, v99
  v_cmp_eq_u32 vcc, -1, v247
  s_cbranch_vccnz L_ob_33
L_obd_34:
  v_mfma_f32_32x32x16_bf16 v[128:143], v[208:211], v[96:99], v[128:143]
  v_mfma_f32_32x32x16_bf16 v[144:159], v[212:215], v[96:99], v[144:159]
  s_waitcnt vmcnt(2)
  v_max3_u32 v247, v100, v101, v102
  v_max_u32 v247, v247, v103
  v_cmp_eq_u32 vcc, -1, v247
  s_cbranch_vccnz L_ob_35
L_obd_36:
  v_mfma_f32_32x32x16_bf16 v[128:143], v[216:219], v[100:103], v[128:143]
  v_mfma_f32_32x32x16_bf16 v[144:159], v[220:223], v[100:103], v[144:159]
  s_waitcnt vmcnt(1)
  v_max3_u32 v247, v104, v105, v106
  v_max_u32 v247, v247, v107
  v_cmp_eq_u32 vcc, -1, v247
  s_cbranch_vccnz L_ob_37
L_obd_38:
  v_mfma_f32_32x32x16_bf16 v[128:143], v[224:227], v[104:107], v[128:143]
  v_mfma_f32_32x32x16_bf16 v[144:159], v[228:231], v[104:107], v[144:159]
  s_waitcnt vmcnt(0)
  v_max3_u32 v247, v108, v109, v110
  v_max_u32 v247, v247, v111
  v_cmp_eq_u32 vcc, -1, v247
  s_cbranch_vccnz L_ob_39
L_obd_40:
  v_mfma_f32_32x32x16_bf16 v[128:143], v[232:235], v[108:111], v[128:143]
  v_mfma_f32_32x32x16_bf16 v[144:159], v[236:239], v[108:111], v[144:159]
  s_bitcmp1_b32 s54, 0
  s_cbranch_scc1 L_kq_42
  s_nop 8
  ds_write_b128 v12, v[136:139] offset:8192
  ds_write_b128 v12, v[140:143] offset:9216
  ds_write_b128 v12, v[144:147] offset:16384
  ds_write_b128 v12, v[148:151] offset:17408
  ds_write_b128 v12, v[152:155] offset:24576
  ds_write_b128 v12, v[156:159] offset:25600
  s_waitcnt lgkmcnt(0)
  s_barrier
  ds_read_b128 v[80:83], v126 offset:2048
  ds_read_b128 v[84:87], v126 offset:3072
  ds_read_b128 v[88:91], v126 offset:4096
  ds_read_b128 v[92:95], v126 offset:5120
  ds_read_b128 v[96:99], v126 offset:6144
  ds_read_b128 v[100:103], v126 offset:7168
  s_waitcnt lgkmcnt(4)
  v_pk_add_f32 v[128:129], v[128:129], v[80:81]
  v_pk_add_f32 v[130:131], v[130:131], v[82:83]
  v_pk_add_f32 v[132:133], v[132:133], v[84:85]
  v_pk_add_f32 v[134:135], v[134:135], v[86:87]
  s_waitcnt lgkmcnt(2)
  v_pk_add_f32 v[128:129], v[128:129], v[88:89]
  v_pk_add_f32 v[130:131], v[130:131], v[90:91]
  v_pk_add_f32 v[132:133], v[132:133], v[92:93]
  v_pk_add_f32 v[134:135], v[134:135], v[94:95]
  s_waitcnt lgkmcnt(0)
  s_nop 0
  v_pk_add_f32 v[128:129], v[128:129], v[96:97]
  v_pk_add_f32 v[130:131], v[130:131], v[98:99]
  v_pk_add_f32 v[132:133], v[132:133], v[100:101]
  v_pk_add_f32 v[134:135], v[134:135], v[102:103]
  v_cvt_pk_bf16_f32 v80, v128, v129
  v_cvt_pk_bf16_f32 v81, v130, v131
  v_cvt_pk_bf16_f32 v82, v132, v133
  v_cvt_pk_bf16_f32 v83, v134, v135
  s_branch L_kqj_43
L_kq_42:
  s_nop 8
  ds_write_b128 v12, v[128:131] offset:0
  ds_write_b128 v12, v[132:135] offset:1024
  ds_write_b128 v12, v[144:147] offset:16384
  ds_write_b128 v12, v[148:151] offset:17408
  ds_write_b128 v12, v[152:155] offset:24576
  ds_write_b128 v12, v[156:159] offset:25600
  s_waitcnt lgkmcnt(0)
  s_barrier
  ds_read_b128 v[80:83], v126 offset:0
  ds_read_b128 v[84:87], v126 offset:1024
  ds_read_b128 v[88:91], v126 offset:4096
  ds_read_b128 v[92:95], v126 offset:5120
  ds_read_b128 v[96:99], v126 offset:6144
  ds_read_b128 v[100:103], v126 offset:7168
  s_waitcnt lgkmcnt(4)
  v_pk_add_f32 v[136:137], v[136:137], v[80:81]
  v_pk_add_f32 v[138:139], v[138:139], v[82:83]
  v_pk_add_f32 v[140:141], v[140:141], v[84:85]
  v_pk_add_f32 v[142:143], v[142:143], v[86:87]
  s_waitcnt lgkmcnt(2)
  v_pk_add_f32 v[136:137], v[136:137], v[88:89]
  v_pk_add_f32 v[138:139], v[138:139], v[90:91]
  v_pk_add_f32 v[140:141], v[140:141], v[92:93]
  v_pk_add_f32 v[142:143], v[142:143], v[94:95]
  s_waitcnt lgkmcnt(0)
  s_nop 0
  v_pk_add_f32 v[136:137], v[136:137], v[96:97]
  v_pk_add_f32 v[138:139], v[138:139], v[98:99]
  v_pk_add_f32 v[140:141], v[140:141], v[100:101]
  v_pk_add_f32 v[142:143], v[142:143], v[102:103]
  v_cvt_pk_bf16_f32 v80, v136, v137
  v_cvt_pk_bf16_f32 v81, v138, v139
  v_cvt_pk_bf16_f32 v82, v140, v141
  v_cvt_pk_bf16_f32 v83, v142, v143
L_kqj_43:
  buffer_store_dwordx4 v[80:83], v14, s[16:19], 0 offen sc1
  s_or_b32 s60, s44, s45
  s_or_b32 s60, s60, s46
  s_cmp_lg_u32 s60, 0
  s_cbranch_scc1 L_ep_44
  v_mov_b32 v247, s60
  v_mov_b32 v248, s51
  s_mov_b64 exec, 1
  buffer_store_dword v248, v247, s[12:15], 0 offen sc1
  s_mov_b64 exec, -1
L_ep_44:
L_idle_24:
  s_endpgm
L_fb_21:
  s_lshl_b32 s60, s47, 12
  v_subrev_u32 v12, s60, v12
  v_mov_b32 v11, 0xff7fffff
  s_mov_b32 s73, 0
  v_mov_b32 v160, 0
  v_mov_b32 v161, 0
  v_mov_b32 v162, 0
  v_mov_b32 v163, 0
  v_mov_b32 v164, 0
  v_mov_b32 v165, 0
  v_mov_b32 v166, 0
  v_mov_b32 v167, 0
  v_mov_b32 v168, 0
  v_mov_b32 v169, 0
  v_mov_b32 v170, 0
  v_mov_b32 v171, 0
  v_mov_b32 v172, 0
  v_mov_b32 v173, 0
  v_mov_b32 v174, 0
  v_mov_b32 v175, 0
L_fbl_23:
  buffer_load_dwordx4 v[136:139], v12, s[12:15], s73 offen sc1
  buffer_load_dwordx4 v[140:143], v12, s[12:15], s73 offen offset:1024 sc1
  buffer_load_dwordx4 v[144:147], v12, s[12:15], s73 offen offset:2048 sc1
  buffer_load_dwordx4 v[148:151], v12, s[12:15], s73 offen offset:3072 sc1
  s_waitcnt vmcnt(0)
  v_mfma_f32_32x32x16_bf16 v[192:207], v[136:139], v[128:131], 0
  v_mfma_f32_32x32x16_bf16 v[192:207], v[140:143], v[132:135], v[192:207]
  s_nop 11
  v_max3_f32 v247, v11, v192, v193
  v_max3_f32 v247, v247, v194, v195
  v_max3_f32 v247, v247, v196, v197
  v_max3_f32 v247, v247, v198, v199
  v_max3_f32 v247, v247, v200, v201
  v_max3_f32 v247, v247, v202, v203
  v_max3_f32 v247, v247, v204, v205
  v_max3_f32 v247, v247, v206, v207
  v_mov_b32 v248, v247
  s_nop 1
  v_permlane32_swap_b32 v247, v248
  v_max_f32 v247, v247, v248
  v_sub_f32 v248, v11, v247
  v_exp_f32 v248, v248
  v_mov_b32 v11, v247
  v_sub_f32 v192, v192, v247
  v_mul_f32 v160, v160, v248
  v_sub_f32 v193, v193, v247
  v_mul_f32 v161, v161, v248
  v_sub_f32 v194, v194, v247
  v_mul_f32 v162, v162, v248
  v_sub_f32 v195, v195, v247
  v_mul_f32 v163, v163, v248
  v_sub_f32 v196, v196, v247
  v_mul_f32 v164, v164, v248
  v_sub_f32 v197, v197, v247
  v_mul_f32 v165, v165, v248
  v_sub_f32 v198, v198, v247
  v_mul_f32 v166, v166, v248
  v_sub_f32 v199, v199, v247
  v_mul_f32 v167, v167, v248
  v_sub_f32 v200, v200, v247
  v_mul_f32 v168, v168, v248
  v_sub_f32 v201, v201, v247
  v_mul_f32 v169, v169, v248
  v_sub_f32 v202, v202, v247
  v_mul_f32 v170, v170, v248
  v_sub_f32 v203, v203, v247
  v_mul_f32 v171, v171, v248
  v_sub_f32 v204, v204, v247
  v_mul_f32 v172, v172, v248
  v_sub_f32 v205, v205, v247
  v_mul_f32 v173, v173, v248
  v_sub_f32 v206, v206, v247
  v_mul_f32 v174, v174, v248
  v_sub_f32 v207, v207, v247
  v_mul_f32 v175, v175, v248
  v_exp_f32 v192, v192
  v_exp_f32 v193, v193
  v_exp_f32 v194, v194
  v_exp_f32 v195, v195
  v_exp_f32 v196, v196
  v_exp_f32 v197, v197
  v_exp_f32 v198, v198
  v_exp_f32 v199, v199
  v_exp_f32 v200, v200
  v_exp_f32 v201, v201
  v_exp_f32 v202, v202
  v_exp_f32 v203, v203
  v_exp_f32 v204, v204
  v_exp_f32 v205, v205
  v_exp_f32 v206, v206
  v_exp_f32 v207, v207
  s_nop 1
  v_smfmac_f32_32x32x32_bf16 v[160:175], v[144:147], v[192:199], v10
  v_smfmac_f32_32x32x32_bf16 v[160:175], v[148:151], v[200:207], v10
  s_add_u32 s73, s73, 4096
  s_cmp_lt_u32 s73, 131072
  s_cbranch_scc1 L_fbl_23
  s_nop 8
  v_mov_b32 v152, v172
  v_mov_b32 v247, v172
  s_nop 1
  v_permlane32_swap_b32 v247, v152
  v_mov_b32 v153, v11
  ds_write_b128 v124, v[168:171]
  ds_write_b128 v124, v[172:175] offset:1024
  ds_write_b64 v5, v[152:153] offset:2048
  s_branch L_fbback_22
L_kp_1:
  s_mov_b32 s75, 262144
L_kp_1_a:
  buffer_load_dword v4, v5, s[12:15], 0 offen sc1
  s_waitcnt vmcnt(0)
  v_cmp_eq_u32 vcc, s51, v4
  s_nop 0
  s_lshr_b32 s76, vcc_lo, 16
  s_and_b32 s76, s76, vcc_lo
  s_lshr_b32 s58, s76, 8
  s_and_b32 s76, s76, s58
  s_and_b32 s76, s76, 0xff
  s_bitcmp1_b32 s76, 0
  s_cbranch_scc1 L_kpd_2
  s_sleep 2
  s_sub_u32 s75, s75, 1
  s_cbranch_scc0 L_kp_1_a
  s_branch L_kpd_2
L_kp_3:
  s_mov_b32 s75, 262144
L_kp_3_a:
  buffer_load_dword v4, v5, s[12:15], 0 offen sc1
  s_waitcnt vmcnt(0)
  v_cmp_eq_u32 vcc, s51, v4
  s_nop 0
  s_lshr_b32 s76, vcc_lo, 16
  s_and_b32 s76, s76, vcc_lo
  s_lshr_b32 s58, s76, 8
  s_and_b32 s76, s76, s58
  s_and_b32 s76, s76, 0xff
  s_bitcmp1_b32 s76, 1
  s_cbranch_scc1 L_kpd_4
  s_sleep 2
  s_sub_u32 s75, s75, 1
  s_cbranch_scc0 L_kp_3_a
  s_branch L_kpd_4
L_kp_5:
  s_mov_b32 s75, 262144
L_kp_5_a:
  buffer_load_dword v4, v5, s[12:15], 0 offen sc1
  s_waitcnt vmcnt(0)
  v_cmp_eq_u32 vcc, s51, v4
  s_nop 0
  s_lshr_b32 s76, vcc_lo, 16
  s_and_b32 s76, s76, vcc_lo
  s_lshr_b32 s58, s76, 8
  s_and_b32 s76, s76, s58
  s_and_b32 s76, s76, 0xff
  s_bitcmp1_b32 s76, 2
  s_cbranch_scc1 L_kpd_6
  s_sleep 2
  s_sub_u32 s75, s75, 1
  s_cbranch_scc0 L_kp_5_a
  s_branch L_kpd_6
L_kp_7:
  s_mov_b32 s75, 262144
L_kp_7_a:
  buffer_load_dword v4, v5, s[12:15], 0 offen sc1
  s_waitcnt vmcnt(0)
  v_cmp_eq_u32 vcc, s51, v4
  s_nop 0
  s_lshr_b32 s76, vcc_lo, 16
  s_and_b32 s76, s76, vcc_lo
  s_lshr_b32 s58, s76, 8
  s_and_b32 s76, s76, s58
  s_and_b32 s76, s76, 0xff
  s_bitcmp1_b32 s76, 3
  s_cbranch_scc1 L_kpd_8
  s_sleep 2
  s_sub_u32 s75, s75, 1
  s_cbranch_scc0 L_kp_7_a
  s_branch L_kpd_8
L_kp_9:
  s_mov_b32 s75, 262144
L_kp_9_a:
  buffer_load_dword v4, v5, s[12:15], 0 offen sc1
  s_waitcnt vmcnt(0)
  v_cmp_eq_u32 vcc, s51, v4
  s_nop 0
  s_lshr_b32 s76, vcc_lo, 16
  s_and_b32 s76, s76, vcc_lo
  s_lshr_b32 s58, s76, 8
  s_and_b32 s76, s76, s58
  s_and_b32 s76, s76, 0xff
  s_bitcmp1_b32 s76, 4
  s_cbranch_scc1 L_kpd_10
  s_sleep 2
  s_sub_u32 s75, s75, 1
  s_cbranch_scc0 L_kp_9_a
  s_branch L_kpd_10
L_kp_11:
  s_mov_b32 s75, 262144
L_kp_11_a:
  buffer_load_dword v4, v5, s[12:15], 0 offen sc1
  s_waitcnt vmcnt(0)
  v_cmp_eq_u32 vcc, s51, v4
  s_nop 0
  s_lshr_b32 s76, vcc_lo, 16
  s_and_b32 s76, s76, vcc_lo
  s_lshr_b32 s58, s76, 8
  s_and_b32 s76, s76, s58
  s_and_b32 s76, s76, 0xff
  s_bitcmp1_b32 s76, 5
  s_cbranch_scc1 L_kpd_12
  s_sleep 2
  s_sub_u32 s75, s75, 1
  s_cbranch_scc0 L_kp_11_a
  s_branch L_kpd_12
L_poll_13:
  s_mov_b32 s75, 262144
L_poll_13_a:
  s_sleep 4
  buffer_load_dword v124, v14, s[12:15], 0 offen sc1
  s_waitcnt vmcnt(0)
  v_cmp_ne_u32 vcc, s51, v124
  s_cbranch_vccz L_polled_14
  s_sub_u32 s75, s75, 1
  s_cbranch_scc0 L_poll_13_a
  s_branch L_polled_14
L_kp_15:
  s_mov_b32 s75, 262144
L_kp_15_a:
  buffer_load_dword v4, v5, s[12:15], 0 offen sc1
  s_waitcnt vmcnt(0)
  v_cmp_eq_u32 vcc, s51, v4
  s_nop 0
  s_lshr_b32 s76, vcc_lo, 16
  s_and_b32 s76, s76, vcc_lo
  s_lshr_b32 s58, s76, 8
  s_and_b32 s76, s76, s58
  s_and_b32 s76, s76, 0xff
  s_bitcmp1_b32 s76, 6
  s_cbranch_scc1 L_kpd_16
  s_sleep 2
  s_sub_u32 s75, s75, 1
  s_cbranch_scc0 L_kp_15_a
  s_branch L_kpd_16
L_kp_17:
  s_mov_b32 s75, 262144
L_kp_17_a:
  buffer_load_dword v4, v5, s[12:15], 0 offen sc1
  s_waitcnt vmcnt(0)
  v_cmp_eq_u32 vcc, s51, v4
  s_nop 0
  s_lshr_b32 s76, vcc_lo, 16
  s_and_b32 s76, s76, vcc_lo
  s_lshr_b32 s58, s76, 8
  s_and_b32 s76, s76, s58
  s_and_b32 s76, s76, 0xff
  s_bitcmp1_b32 s76, 7
  s_cbranch_scc1 L_kpd_18
  s_sleep 2
  s_sub_u32 s75, s75, 1
  s_cbranch_scc0 L_kp_17_a
  s_branch L_kpd_18
L_poll_19:
  s_mov_b32 s75, 262144
L_poll_19_a:
  s_sleep 4
  buffer_load_dword v244, v245, s[12:15], 0 offen sc1
  s_waitcnt vmcnt(0)
  v_cmp_ne_u32 vcc, s51, v244
  s_cbranch_vccz L_polled_20
  s_sub_u32 s75, s75, 1
  s_cbranch_scc0 L_poll_19_a
  s_branch L_polled_20
L_ob_25:
  s_sleep 6
  buffer_load_dwordx4 v[80:83], v9, s[12:15], 0 offen offset:0 sc1
  buffer_load_dwordx4 v[84:87], v9, s[12:15], 0 offen offset:1024 sc1
  buffer_load_dwordx4 v[88:91], v9, s[12:15], 0 offen offset:2048 sc1
  buffer_load_dwordx4 v[92:95], v9, s[12:15], 0 offen offset:3072 sc1
  buffer_load_dwordx4 v[96:99], v9, s[12:15], s52 offen offset:0 sc1
  buffer_load_dwordx4 v[100:103], v9, s[12:15], s52 offen offset:1024 sc1
  buffer_load_dwordx4 v[104:107], v9, s[12:15], s52 offen offset:2048 sc1
  buffer_load_dwordx4 v[108:111], v9, s[12:15], s52 offen offset:3072 sc1
  s_waitcnt vmcnt(7)
  v_max3_u32 v247, v80, v81, v82
  v_max_u32 v247, v247, v83
  v_cmp_eq_u32 vcc, -1, v247
  s_sub_u32 s75, s75, 1
  s_cbranch_scc1 L_obd_26
  s_cbranch_vccnz L_ob_25
  s_branch L_obd_26
L_ob_27:
  s_sleep 6
  buffer_load_dwordx4 v[84:87], v9, s[12:15], 0 offen offset:1024 sc1
  buffer_load_dwordx4 v[88:91], v9, s[12:15], 0 offen offset:2048 sc1
  buffer_load_dwordx4 v[92:95], v9, s[12:15], 0 offen offset:3072 sc1
  buffer_load_dwordx4 v[96:99], v9, s[12:15], s52 offen offset:0 sc1
  buffer_load_dwordx4 v[100:103], v9, s[12:15], s52 offen offset:1024 sc1
  buffer_load_dwordx4 v[104:107], v9, s[12:15], s52 offen offset:2048 sc1
  buffer_load_dwordx4 v[108:111], v9, s[12:15], s52 offen offset:3072 sc1
  s_waitcnt vmcnt(6)
  v_max3_u32 v247, v84, v85, v86
  v_max_u32 v247, v247, v87
  v_cmp_eq_u32 vcc, -1, v247
  s_sub_u32 s75, s75, 1
  s_cbranch_scc1 L_obd_28
  s_cbranch_vccnz L_ob_27
  s_branch L_obd_28
L_ob_29:
  s_sleep 6
  buffer_load_dwordx4 v[88:91], v9, s[12:15], 0 offen offset:2048 sc1
  buffer_load_dwordx4 v[92:95], v9, s[12:15], 0 offen offset:3072 sc1
  buffer_load_dwordx4 v[96:99], v9, s[12:15], s52 offen offset:0 sc1
  buffer_load_dwordx4 v[100:103], v9, s[12:15], s52 offen offset:1024 sc1
  buffer_load_dwordx4 v[104:107], v9, s[12:15], s52 offen offset:2048 sc1
  buffer_load_dwordx4 v[108:111], v9, s[12:15], s52 offen offset:3072 sc1
  s_waitcnt vmcnt(5)
  v_max3_u32 v247, v88, v89, v90
  v_max_u32 v247, v247, v91
  v_cmp_eq_u32 vcc, -1, v247
  s_sub_u32 s75, s75, 1
  s_cbranch_scc1 L_obd_30
  s_cbranch_vccnz L_ob_29
  s_branch L_obd_30
L_ob_31:
  s_sleep 6
  buffer_load_dwordx4 v[92:95], v9, s[12:15], 0 offen offset:3072 sc1
  buffer_load_dwordx4 v[96:99], v9, s[12:15], s52 offen offset:0 sc1
  buffer_load_dwordx4 v[100:103], v9, s[12:15], s52 offen offset:1024 sc1
  buffer_load_dwordx4 v[104:107], v9, s[12:15], s52 offen offset:2048 sc1
  buffer_load_dwordx4 v[108:111], v9, s[12:15], s52 offen offset:3072 sc1
  s_waitcnt vmcnt(4)
  v_max3_u32 v247, v92, v93, v94
  v_max_u32 v247, v247, v95
  v_cmp_eq_u32 vcc, -1, v247
  s_sub_u32 s75, s75, 1
  s_cbranch_scc1 L_obd_32
  s_cbranch_vccnz L_ob_31
  s_branch L_obd_32
L_ob_33:
  s_sleep 6
  buffer_load_dwordx4 v[96:99], v9, s[12:15], s52 offen offset:0 sc1
  buffer_load_dwordx4 v[100:103], v9, s[12:15], s52 offen offset:1024 sc1
  buffer_load_dwordx4 v[104:107], v9, s[12:15], s52 offen offset:2048 sc1
  buffer_load_dwordx4 v[108:111], v9, s[12:15], s52 offen offset:3072 sc1
  s_waitcnt vmcnt(3)
  v_max3_u32 v247, v96, v97, v98
  v_max_u32 v247, v247, v99
  v_cmp_eq_u32 vcc, -1, v247
  s_sub_u32 s75, s75, 1
  s_cbranch_scc1 L_obd_34
  s_cbranch_vccnz L_ob_33
  s_branch L_obd_34
L_ob_35:
  s_sleep 6
  buffer_load_dwordx4 v[100:103], v9, s[12:15], s52 offen offset:1024 sc1
  buffer_load_dwordx4 v[104:107], v9, s[12:15], s52 offen offset:2048 sc1
  buffer_load_dwordx4 v[108:111], v9, s[12:15], s52 offen offset:3072 sc1
  s_waitcnt vmcnt(2)
  v_max3_u32 v247, v100, v101, v102
  v_max_u32 v247, v247, v103
  v_cmp_eq_u32 vcc, -1, v247
  s_sub_u32 s75, s75, 1
  s_cbranch_scc1 L_obd_36
  s_cbranch_vccnz L_ob_35
  s_branch L_obd_36
L_ob_37:
  s_sleep 6
  buffer_load_dwordx4 v[104:107], v9, s[12:15], s52 offen offset:2048 sc1
  buffer_load_dwordx4 v[108:111], v9, s[12:15], s52 offen offset:3072 sc1
  s_waitcnt vmcnt(1)
  v_max3_u32 v247, v104, v105, v106
  v_max_u32 v247, v247, v107
  v_cmp_eq_u32 vcc, -1, v247
  s_sub_u32 s75, s75, 1
  s_cbranch_scc1 L_obd_38
  s_cbranch_vccnz L_ob_37
  s_branch L_obd_38
L_ob_39:
  s_sleep 6
  buffer_load_dwordx4 v[108:111], v9, s[12:15], s52 offen offset:3072 sc1
  s_waitcnt vmcnt(0)
  v_max3_u32 v247, v108, v109, v110
  v_max_u32 v247, v247, v111
  v_cmp_eq_u32 vcc, -1, v247
  s_sub_u32 s75, s75, 1
  s_cbranch_scc1 L_obd_40
  s_cbranch_vccnz L_ob_39
  s_branch L_obd_40
L_grp1:
  s_cmp_gt_u32 s44, 5
  s_subb_u32 s50, s44, 0
  s_cmp_gt_u32 s44, 10
  s_subb_u32 s50, s50, 0
  s_xor_b32 s49, s44, 1
  s_mov_b32 s64, 1901081188
  s_mov_b32 s65, 3118267112
  s_lshl_b32 s60, s44, 2
  s_lshr_b64 s[64:65], s[64:65], s60
  s_and_b32 s53, s64, 15
  s_getpc_b64 s[64:65]
L_pc:
  s_lshl2_add_u32 s60, s59, s47
  s_mul_i32 s60, s60, 320
  s_min_u32 s60, s60, L_end-gated_mix__linear_kernel_hedgehog__softmax_full_mha__prompt_kernel-320
  s_sub_u32 s64, s64, L_pc-gated_mix__linear_kernel_hedgehog__softmax_full_mha__prompt_kernel
  s_subb_u32 s65, s65, 0
  s_add_u32 s64, s64, s60
  s_addc_u32 s65, s65, 0
  s_waitcnt lgkmcnt(0)
  s_load_dword s51, s[40:41], 0
  s_load_dword s75, s[64:65], 0
  s_load_dword s75, s[64:65], 64
  s_load_dword s75, s[64:65], 128
  s_load_dword s75, s[64:65], 192
  s_load_dword s75, s[64:65], 256
  s_lshl4_add_u32 s60, s50, s45
  s_lshl2_add_u32 s60, s60, s47
  s_lshl_b32 s60, s60, 6
  s_add_u32 s61, s60, 262144
  s_load_dword s75, s[40:41], s61
  s_lshl3_add_u32 s60, s49, s47
  s_lshl4_add_u32 s60, s60, s45
  s_lshl_b32 s60, s60, 6
  s_add_u32 s61, s60, 131072
  s_load_dword s75, s[40:41], s61
  s_add_u32 s61, s60, 135168
  s_load_dword s75, s[40:41], s61
  s_lshl2_add_u32 s62, s45, s47
  s_lshl4_add_u32 s60, s62, s53
  s_lshl_b32 s60, s60, 6
  s_add_u32 s61, s60, 393216
  s_load_dword s75, s[40:41], s61
  s_lshl4_add_u32 s60, s62, s44
  s_lshl_b32 s60, s60, 7
  s_add_u32 s61, s60, 524288
  s_load_dword s75, s[40:41], s61
  s_add_u32 s61, s60, 524352
  s_load_dword s75, s[40:41], s61
  s_mul_i32 s60, s45, 3
  s_lshl1_add_u32 s52, s44, s60
  s_mul_i32 s60, s52, 147
  s_lshr_b32 s60, s60, 10
  s_mul_i32 s60, s60, 7
  s_sub_u32 s52, s52, s60
  s_lshl_b32 s91, s52, 7
  s_add_u32 s92, s91, 128
  s_cmp_eq_u32 s92, 896
  s_cselect_b32 s92, 0, s92
  s_mul_i32 s85, s92, 1344
  s_add_u32 s93, s92, 128
  s_cmp_eq_u32 s93, 896
  s_cselect_b32 s93, 0, s93
  s_mul_i32 s86, s93, 1344
  s_add_u32 s94, s93, 128
  s_cmp_eq_u32 s94, 896
  s_cselect_b32 s94, 0, s94
  s_mul_i32 s87, s94, 1344
  s_add_u32 s95, s94, 128
  s_cmp_eq_u32 s95, 896
  s_cselect_b32 s95, 0, s95
  s_mul_i32 s88, s95, 1344
  s_add_u32 s96, s95, 128
  s_cmp_eq_u32 s96, 896
  s_cselect_b32 s96, 0, s96
  s_mul_i32 s89, s96, 1344
  s_add_u32 s97, s96, 128
  s_cmp_eq_u32 s97, 896
  s_cselect_b32 s97, 0, s97
  s_mul_i32 s90, s97, 1344
  v_and_b32 v2, 31, v1
  v_lshrrev_b32 v3, 5, v1
  v_bfe_u32 v247, v1, 1, 3
  v_xor_b32 v247, v247, v3
  v_lshlrev_b32 v247, 4, v247
  v_lshl_add_u32 v247, v2, 7, v247
  s_lshl_b32 s60, s47, 12
  v_add_u32 v8, s60, v247
  v_xor_b32 v9, 32, v8
  v_xor_b32 v10, 64, v8
  v_xor_b32 v11, 96, v8
  s_mov_b32 s78, 0
  s_mov_b32 s79, -1
  s_mov_b32 s12, s40
  s_mov_b32 s13, s41
  s_mov_b32 s14, 33554432
  s_mov_b32 s15, 0x20000
  s_cmp_ge_u32 s50, 7
  s_cbranch_scc1 L_vtile
  v_and_b32 v247, 1, v1
  v_bfe_u32 v248, v1, 1, 1
  v_lshl_or_b32 v247, v247, 1, v248
  v_bfe_u32 v248, v1, 4, 1
  v_lshl_or_b32 v247, v248, 2, v247
  v_bfe_u32 v248, v1, 2, 2
  v_lshl_or_b32 v248, v3, 3, v248
  v_bfe_u32 v249, v1, 3, 1
  v_lshlrev_b32 v249, 6, v249
  v_lshl_add_u32 v249, v247, 3, v249
  v_lshl_add_u32 v249, v248, 7, v249
  v_add_u32 v12, 98304, v249
  v_xor_b32 v13, 64, v12
  s_waitcnt lgkmcnt(0)
  s_barrier
  ds_read_b128 v[128:131], v8 offset:0
  ds_read_b64_tr_b16 v[96:97], v12 offset:0
  ds_read_b64_tr_b16 v[98:99], v12 offset:512
  ds_read_b64_tr_b16 v[48:49], v13 offset:0
  ds_read_b64_tr_b16 v[50:51], v13 offset:512
  ds_read_b128 v[132:135], v9 offset:0
  ds_read_b64_tr_b16 v[100:101], v12 offset:2048
  ds_read_b64_tr_b16 v[102:103], v12 offset:2560
  ds_read_b64_tr_b16 v[52:53], v13 offset:2048
  ds_read_b64_tr_b16 v[54:55], v13 offset:2560
  ds_read_b128 v[136:139], v10 offset:0
  ds_read_b64_tr_b16 v[104:105], v12 offset:4096
  ds_read_b64_tr_b16 v[106:107], v12 offset:4608
  ds_read_b64_tr_b16 v[56:57], v13 offset:4096
  ds_read_b64_tr_b16 v[58:59], v13 offset:4608
  ds_read_b128 v[140:143], v11 offset:0
  ds_read_b64_tr_b16 v[108:109], v12 offset:6144
  ds_read_b64_tr_b16 v[110:111], v12 offset:6656
  ds_read_b64_tr_b16 v[60:61], v13 offset:6144
  ds_read_b64_tr_b16 v[62:63], v13 offset:6656
  s_lshl_b32 s60, s45, 2
  s_add_u32 s60, s60, s47
  s_lshl_b32 s60, s60, 16
  s_lshl_b32 s61, s44, 11
  s_add_u32 s60, s60, s61
  s_add_u32 s60, s60, 8422400
  v_lshl_add_u32 v246, v1, 4, s60
  s_add_u32 s51, s51, 0x9e3779b0
  s_lshr_b32 s60, s46, 1
  s_lshl_b32 s61, s60, 2
  v_and_b32 v247, 3, v1
  v_or_b32_e64 v247, s61, v247
  v_bfe_u32 v248, v1, 2, 1
  v_bfe_u32 v240, v1, 4, 1
  v_lshl_or_b32 v248, v240, 1, v248
  v_bfe_u32 v241, v1, 3, 1
  v_lshl_or_b32 v248, v241, 3, v248
  v_xor_b32 v247, v247, v248
  v_bfe_u32 v248, v1, 2, 2
  v_lshl_or_b32 v248, v240, 2, v248
  v_lshl_or_b32 v248, v3, 4, v248
  v_lshlrev_b32 v247, 3, v247
  v_lshl_add_u32 v247, v248, 7, v247
  v_and_b32 v248, 15, v1
  s_and_b32 s61, s46, 1
  s_lshl_b32 s61, s61, 4
  v_add_u32 v248, s61, v248
  s_lshl3_add_u32 s61, s49, s46
  s_lshl4_add_u32 s61, s61, s45
  s_lshl_b32 s61, s61, 9
  s_add_u32 s61, s61, 5242880
  v_and_b32 v243, 15, v1
  v_lshl_or_b32 v243, v3, 4, v243
  v_lshl_or_b32 v243, v243, 1, v240
  v_lshl_add_u32 v243, v243, 3, s61
  v_lshlrev_b32 v248, 4, v248
  v_lshrrev_b32 v242, 4, v1
  v_lshl_add_u32 v242, v242, 9, v248
  v_add_u32 v242, 122880, v242
  v_add_u32 v240, 98304, v247
  v_add_u32 v241, 1024, v240
  v_xor_b32 v241, 32, v241
  s_waitcnt lgkmcnt(0)
  s_barrier
  s_nop 0
  v_mfma_f32_32x32x16_bf16 v[16:31], v[96:99], v[128:131], 0
  ds_read_b128 v[144:147], v8 offset:16384
  ds_read_b64_tr_b16 v[112:113], v12 offset:8192
  ds_read_b64_tr_b16 v[114:115], v12 offset:8704
  v_mfma_f32_32x32x16_bf16 v[32:47], v[48:51], v[128:131], 0
  ds_read_b64_tr_b16 v[80:81], v13 offset:8192
  ds_read_b64_tr_b16 v[82:83], v13 offset:8704
  ds_read_b128 v[148:151], v9 offset:16384
  s_lshl_b32 s60, s50, 3
  v_and_b32 v247, 0x13, v2
  v_bfe_u32 v248, v2, 2, 1
  v_lshl_or_b32 v247, v248, 3, v247
  v_bfe_u32 v248, v2, 3, 1
  v_lshl_or_b32 v247, v248, 2, v247
  v_lshlrev_b32 v247, 4, v247
  s_lshl_b32 s61, s45, 2
  s_add_u32 s61, s61, s47
  s_lshl_b32 s61, s61, 12
  s_add_u32 s61, s61, 1048576
  v_add_u32 v72, s61, v247
  v_add_u32 v73, s60, v3
  v_mfma_f32_32x32x16_bf16 v[16:31], v[100:103], v[132:135], v[16:31]
  ds_read_b64_tr_b16 v[116:117], v12 offset:10240
  ds_read_b64_tr_b16 v[118:119], v12 offset:10752
  ds_read_b64_tr_b16 v[84:85], v13 offset:10240
  ds_read_b64_tr_b16 v[86:87], v13 offset:10752
  v_mfma_f32_32x32x16_bf16 v[32:47], v[52:55], v[132:135], v[32:47]
  ds_read_b128 v[152:155], v10 offset:16384
  ds_read_b64_tr_b16 v[120:121], v12 offset:12288
  ds_read_b64_tr_b16 v[122:123], v12 offset:12800
  v_mfma_f32_32x32x16_bf16 v[16:31], v[104:107], v[136:139], v[16:31]
  ds_read_b64_tr_b16 v[88:89], v13 offset:12288
  ds_read_b64_tr_b16 v[90:91], v13 offset:12800
  ds_read_b128 v[156:159], v11 offset:16384
  v_mfma_f32_32x32x16_bf16 v[32:47], v[56:59], v[136:139], v[32:47]
  ds_read_b64_tr_b16 v[124:125], v12 offset:14336
  ds_read_b64_tr_b16 v[126:127], v12 offset:14848
  ds_read_b64_tr_b16 v[92:93], v13 offset:14336
  ds_read_b64_tr_b16 v[94:95], v13 offset:14848
  v_add_u32 v248, 0, v73
  v_mul_u32_u24 v249, 37, v248
  v_lshrrev_b32 v249, 8, v249
  v_mul_u32_u24 v250, 7, v249
  v_sub_u32 v250, v248, v250
  v_lshrrev_b32 v251, 2, v250
  v_lshl_add_u32 v252, v249, 1, v251
  v_mul_u32_u24 v251, 3, v251
  v_sub_u32 v251, v250, v251
  v_lshl_add_u32 v64, v252, 18, v72
  v_lshl_add_u32 v64, v251, 9, v64
  v_lshl_add_u32 v66, v249, 19, v72
  v_add_u32 v66, 0x40000, v66
  v_xor_b32 v250, 3, v250
  v_min_u32 v250, 1, v250
  v_lshl_or_b32 v66, v250, 30, v66
  v_mfma_f32_32x32x16_bf16 v[16:31], v[108:111], v[140:143], v[16:31]
  v_mfma_f32_32x32x16_bf16 v[32:47], v[60:63], v[140:143], v[32:47]
  s_waitcnt lgkmcnt(0)
  s_barrier
  v_mfma_f32_32x32x16_bf16 v[16:31], v[112:115], v[144:147], v[16:31]
  ds_read_b128 v[160:163], v8 offset:32768
  ds_read_b64_tr_b16 v[96:97], v12 offset:16384
  ds_read_b64_tr_b16 v[98:99], v12 offset:16896
  v_mfma_f32_32x32x16_bf16 v[32:47], v[80:83], v[144:147], v[32:47]
  ds_read_b64_tr_b16 v[48:49], v13 offset:16384
  ds_read_b64_tr_b16 v[50:51], v13 offset:16896
  ds_read_b128 v[164:167], v9 offset:32768
  v_add_u32 v248, 2, v73
  v_mul_u32_u24 v249, 37, v248
  v_lshrrev_b32 v249, 8, v249
  v_mul_u32_u24 v250, 7, v249
  v_sub_u32 v250, v248, v250
  v_lshrrev_b32 v251, 2, v250
  v_lshl_add_u32 v252, v249, 1, v251
  v_mul_u32_u24 v251, 3, v251
  v_sub_u32 v251, v250, v251
  v_lshl_add_u32 v65, v252, 18, v72
  v_lshl_add_u32 v65, v251, 9, v65
  v_lshl_add_u32 v67, v249, 19, v72
  v_add_u32 v67, 0x40000, v67
  v_xor_b32 v250, 3, v250
  v_min_u32 v250, 1, v250
  v_lshl_or_b32 v67, v250, 30, v67
  v_mfma_f32_32x32x16_bf16 v[16:31], v[116:119], v[148:151], v[16:31]
  ds_read_b64_tr_b16 v[100:101], v12 offset:18432
  ds_read_b64_tr_b16 v[102:103], v12 offset:18944
  ds_read_b64_tr_b16 v[52:53], v13 offset:18432
  ds_read_b64_tr_b16 v[54:55], v13 offset:18944
  v_mfma_f32_32x32x16_bf16 v[32:47], v[84:87], v[148:151], v[32:47]
  ds_read_b128 v[168:171], v10 offset:32768
  ds_read_b64_tr_b16 v[104:105], v12 offset:20480
  ds_read_b64_tr_b16 v[106:107], v12 offset:20992
  v_mfma_f32_32x32x16_bf16 v[16:31], v[120:123], v[152:155], v[16:31]
  ds_read_b64_tr_b16 v[56:57], v13 offset:20480
  ds_read_b64_tr_b16 v[58:59], v13 offset:20992
  ds_read_b128 v[172:175], v11 offset:32768
  v_add_u32 v248, 4, v73
  v_mul_u32_u24 v249, 37, v248
  v_lshrrev_b32 v249, 8, v249
  v_mul_u32_u24 v250, 7, v249
  v_sub_u32 v250, v248, v250
  v_lshrrev_b32 v251, 2, v250
  v_lshl_add_u32 v252, v249, 1, v251
  v_mul_u32_u24 v251, 3, v251
  v_sub_u32 v251, v250, v251
  v_lshl_add_u32 v68, v252, 18, v72
  v_lshl_add_u32 v68, v251, 9, v68
  v_lshl_add_u32 v70, v249, 19, v72
  v_add_u32 v70, 0x40000, v70
  v_xor_b32 v250, 3, v250
  v_min_u32 v250, 1, v250
  v_lshl_or_b32 v70, v250, 30, v70
  v_mfma_f32_32x32x16_bf16 v[32:47], v[88:91], v[152:155], v[32:47]
  ds_read_b64_tr_b16 v[108:109], v12 offset:22528
  ds_read_b64_tr_b16 v[110:111], v12 offset:23040
  ds_read_b64_tr_b16 v[60:61], v13 offset:22528
  ds_read_b64_tr_b16 v[62:63], v13 offset:23040
  v_mfma_f32_32x32x16_bf16 v[16:31], v[124:127], v[156:159], v[16:31]
  v_add_u32 v248, 6, v73
  v_mul_u32_u24 v249, 37, v248
  v_lshrrev_b32 v249, 8, v249
  v_mul_u32_u24 v250, 7, v249
  v_sub_u32 v250, v248, v250
  v_lshrrev_b32 v251, 2, v250
  v_lshl_add_u32 v252, v249, 1, v251
  v_mul_u32_u24 v251, 3, v251
  v_sub_u32 v251, v250, v251
  v_lshl_add_u32 v69, v252, 18, v72
  v_lshl_add_u32 v69, v251, 9, v69
  v_lshl_add_u32 v71, v249, 19, v72
  v_add_u32 v71, 0x40000, v71
  v_xor_b32 v250, 3, v250
  v_min_u32 v250, 1, v250
  v_lshl_or_b32 v71, v250, 30, v71
  v_mfma_f32_32x32x16_bf16 v[32:47], v[92:95], v[156:159], v[32:47]
  s_waitcnt lgkmcnt(0)
  s_barrier
  v_mfma_f32_32x32x16_bf16 v[16:31], v[96:99], v[160:163], v[16:31]
  ds_read_b128 v[176:179], v8 offset:49152
  ds_read_b64_tr_b16 v[112:113], v12 offset:24576
  ds_read_b64_tr_b16 v[114:115], v12 offset:25088
  v_mfma_f32_32x32x16_bf16 v[32:47], v[48:51], v[160:163], v[32:47]
  ds_read_b64_tr_b16 v[80:81], v13 offset:24576
  ds_read_b64_tr_b16 v[82:83], v13 offset:25088
  ds_read_b128 v[180:183], v9 offset:49152
  v_mfma_f32_32x32x16_bf16 v[16:31], v[100:103], v[164:167], v[16:31]
  ds_read_b64_tr_b16 v[116:117], v12 offset:26624
  ds_read_b64_tr_b16 v[118:119], v12 offset:27136
  ds_read_b64_tr_b16 v[84:85], v13 offset:26624
  ds_read_b64_tr_b16 v[86:87], v13 offset:27136
  v_mfma_f32_32x32x16_bf16 v[32:47], v[52:55], v[164:167], v[32:47]
  ds_read_b128 v[184:187], v10 offset:49152
  ds_read_b64_tr_b16 v[120:121], v12 offset:28672
  ds_read_b64_tr_b16 v[122:123], v12 offset:29184
  v_mfma_f32_32x32x16_bf16 v[16:31], v[104:107], v[168:171], v[16:31]
  ds_read_b64_tr_b16 v[88:89], v13 offset:28672
  ds_read_b64_tr_b16 v[90:91], v13 offset:29184
  ds_read_b128 v[188:191], v11 offset:49152
  s_cmp_eq_u32 s44, 5
  s_cselect_b32 s62, 0, 33554432
  s_cmp_eq_u32 s44, 10
  s_cselect_b32 s18, 0, s62
  s_mov_b32 s16, s40
  s_mov_b32 s17, s41
  s_mov_b32 s19, 0x20000
  v_mfma_f32_32x32x16_bf16 v[32:47], v[56:59], v[168:171], v[32:47]
  ds_read_b64_tr_b16 v[124:125], v12 offset:30720
  ds_read_b64_tr_b16 v[126:127], v12 offset:31232
  ds_read_b64_tr_b16 v[92:93], v13 offset:30720
  ds_read_b64_tr_b16 v[94:95], v13 offset:31232
  v_mfma_f32_32x32x16_bf16 v[16:31], v[108:111], v[172:175], v[16:31]
  v_mfma_f32_32x32x16_bf16 v[32:47], v[60:63], v[172:175], v[32:47]
  s_waitcnt lgkmcnt(0)
  s_barrier
  s_nop 0
  v_mfma_f32_32x32x16_bf16 v[16:31], v[112:115], v[176:179], v[16:31]
  ds_read_b128 v[192:195], v8 offset:0
  ds_read_b64_tr_b16 v[96:97], v12 offset:32768
  ds_read_b64_tr_b16 v[98:99], v12 offset:33280
  v_mfma_f32_32x32x16_bf16 v[32:47], v[80:83], v[176:179], v[32:47]
  ds_read_b64_tr_b16 v[48:49], v13 offset:32768
  ds_read_b64_tr_b16 v[50:51], v13 offset:33280
  ds_read_b128 v[196:199], v9 offset:0
  v_mfma_f32_32x32x16_bf16 v[16:31], v[116:119], v[180:183], v[16:31]
  ds_read_b64_tr_b16 v[100:101], v12 offset:34816
  ds_read_b64_tr_b16 v[102:103], v12 offset:35328
  ds_read_b64_tr_b16 v[52:53], v13 offset:34816
  ds_read_b64_tr_b16 v[54:55], v13 offset:35328
  v_mfma_f32_32x32x16_bf16 v[32:47], v[84:87], v[180:183], v[32:47]
  ds_read_b128 v[200:203], v10 offset:0
  ds_read_b64_tr_b16 v[104:105], v12 offset:36864
  ds_read_b64_tr_b16 v[106:107], v12 offset:37376
  v_mfma_f32_32x32x16_bf16 v[16:31], v[120:123], v[184:187], v[16:31]
  ds_read_b64_tr_b16 v[56:57], v13 offset:36864
  ds_read_b64_tr_b16 v[58:59], v13 offset:37376
  ds_read_b128 v[204:207], v11 offset:0
  v_mfma_f32_32x32x16_bf16 v[32:47], v[88:91], v[184:187], v[32:47]
  ds_read_b64_tr_b16 v[108:109], v12 offset:38912
  ds_read_b64_tr_b16 v[110:111], v12 offset:39424
  ds_read_b64_tr_b16 v[60:61], v13 offset:38912
  ds_read_b64_tr_b16 v[62:63], v13 offset:39424
  v_mfma_f32_32x32x16_bf16 v[16:31], v[124:127], v[188:191], v[16:31]
  v_mfma_f32_32x32x16_bf16 v[32:47], v[92:95], v[188:191], v[32:47]
  s_waitcnt lgkmcnt(0)
  s_barrier
  v_mfma_f32_32x32x16_bf16 v[16:31], v[96:99], v[192:195], v[16:31]
  ds_read_b128 v[208:211], v8 offset:16384
  ds_read_b64_tr_b16 v[112:113], v12 offset:40960
  ds_read_b64_tr_b16 v[114:115], v12 offset:41472
  v_mfma_f32_32x32x16_bf16 v[32:47], v[48:51], v[192:195], v[32:47]
  ds_read_b64_tr_b16 v[80:81], v13 offset:40960
  ds_read_b64_tr_b16 v[82:83], v13 offset:41472
  ds_read_b128 v[212:215], v9 offset:16384
  v_mfma_f32_32x32x16_bf16 v[16:31], v[100:103], v[196:199], v[16:31]
  ds_read_b64_tr_b16 v[116:117], v12 offset:43008
  ds_read_b64_tr_b16 v[118:119], v12 offset:43520
  ds_read_b64_tr_b16 v[84:85], v13 offset:43008
  ds_read_b64_tr_b16 v[86:87], v13 offset:43520
  v_mfma_f32_32x32x16_bf16 v[32:47], v[52:55], v[196:199], v[32:47]
  ds_read_b128 v[216:219], v10 offset:16384
  ds_read_b64_tr_b16 v[120:121], v12 offset:45056
  ds_read_b64_tr_b16 v[122:123], v12 offset:45568
  v_mfma_f32_32x32x16_bf16 v[16:31], v[104:107], v[200:203], v[16:31]
  ds_read_b64_tr_b16 v[88:89], v13 offset:45056
  ds_read_b64_tr_b16 v[90:91], v13 offset:45568
  ds_read_b128 v[220:223], v11 offset:16384
  v_mfma_f32_32x32x16_bf16 v[32:47], v[56:59], v[200:203], v[32:47]
  ds_read_b64_tr_b16 v[124:125], v12 offset:47104
  ds_read_b64_tr_b16 v[126:127], v12 offset:47616
  ds_read_b64_tr_b16 v[92:93], v13 offset:47104
  ds_read_b64_tr_b16 v[94:95], v13 offset:47616
  v_mfma_f32_32x32x16_bf16 v[16:31], v[108:111], v[204:207], v[16:31]
  v_mfma_f32_32x32x16_bf16 v[32:47], v[60:63], v[204:207], v[32:47]
  s_waitcnt lgkmcnt(0)
  s_barrier
  v_mfma_f32_32x32x16_bf16 v[16:31], v[112:115], v[208:211], v[16:31]
  ds_read_b128 v[224:227], v8 offset:32768
  ds_read_b64_tr_b16 v[96:97], v12 offset:49152
  ds_read_b64_tr_b16 v[98:99], v12 offset:49664
  v_mfma_f32_32x32x16_bf16 v[32:47], v[80:83], v[208:211], v[32:47]
  ds_read_b64_tr_b16 v[48:49], v13 offset:49152
  ds_read_b64_tr_b16 v[50:51], v13 offset:49664
  ds_read_b128 v[228:231], v9 offset:32768
  v_mfma_f32_32x32x16_bf16 v[16:31], v[116:119], v[212:215], v[16:31]
  ds_read_b64_tr_b16 v[100:101], v12 offset:51200
  ds_read_b64_tr_b16 v[102:103], v12 offset:51712
  ds_read_b64_tr_b16 v[52:53], v13 offset:51200
  ds_read_b64_tr_b16 v[54:55], v13 offset:51712
  v_mfma_f32_32x32x16_bf16 v[32:47], v[84:87], v[212:215], v[32:47]
  ds_read_b128 v[232:235], v10 offset:32768
  ds_read_b64_tr_b16 v[104:105], v12 offset:53248
  ds_read_b64_tr_b16 v[106:107], v12 offset:53760
  v_mfma_f32_32x32x16_bf16 v[16:31], v[120:123], v[216:219], v[16:31]
  ds_read_b64_tr_b16 v[56:57], v13 offset:53248
  ds_read_b64_tr_b16 v[58:59], v13 offset:53760
  ds_read_b128 v[236:239], v11 offset:32768
  v_mfma_f32_32x32x16_bf16 v[32:47], v[88:91], v[216:219], v[32:47]
  ds_read_b64_tr_b16 v[108:109], v12 offset:55296
  ds_read_b64_tr_b16 v[110:111], v12 offset:55808
  ds_read_b64_tr_b16 v[60:61], v13 offset:55296
  ds_read_b64_tr_b16 v[62:63], v13 offset:55808
  v_mfma_f32_32x32x16_bf16 v[16:31], v[124:127], v[220:223], v[16:31]
  v_mfma_f32_32x32x16_bf16 v[32:47], v[92:95], v[220:223], v[32:47]
  s_waitcnt lgkmcnt(0)
  v_mfma_f32_32x32x16_bf16 v[16:31], v[96:99], v[224:227], v[16:31]
  v_mfma_f32_32x32x16_bf16 v[32:47], v[48:51], v[224:227], v[32:47]
  v_mfma_f32_32x32x16_bf16 v[16:31], v[100:103], v[228:231], v[16:31]
  v_mfma_f32_32x32x16_bf16 v[32:47], v[52:55], v[228:231], v[32:47]
  v_mfma_f32_32x32x16_bf16 v[16:31], v[104:107], v[232:235], v[16:31]
  v_mfma_f32_32x32x16_bf16 v[32:47], v[56:59], v[232:235], v[32:47]
  v_mfma_f32_32x32x16_bf16 v[16:31], v[108:111], v[236:239], v[16:31]
  v_mfma_f32_32x32x16_bf16 v[32:47], v[60:63], v[236:239], v[32:47]
  s_setprio 3
  s_nop 9
  v_cvt_pk_bf16_f32 v48, v16, v17
  v_cvt_pk_bf16_f32 v49, v18, v19
  v_cvt_pk_bf16_f32 v50, v20, v21
  v_cvt_pk_bf16_f32 v51, v22, v23
  v_cmp_gt_u32 vcc, 1073741824, v66
  s_cbranch_vccz L_dup_49
  buffer_store_dwordx4 v[48:51], v66, s[16:19], 0 offen sc1
L_dup_49:
  buffer_store_dwordx4 v[48:51], v64, s[16:19], 0 offen sc1
  v_cvt_pk_bf16_f32 v52, v24, v25
  v_cvt_pk_bf16_f32 v53, v26, v27
  v_cvt_pk_bf16_f32 v54, v28, v29
  v_cvt_pk_bf16_f32 v55, v30, v31
  v_cmp_gt_u32 vcc, 1073741824, v67
  s_cbranch_vccz L_dup_50
  buffer_store_dwordx4 v[52:55], v67, s[16:19], 0 offen sc1
L_dup_50:
  buffer_store_dwordx4 v[52:55], v65, s[16:19], 0 offen sc1
  v_cvt_pk_bf16_f32 v56, v32, v33
  v_cvt_pk_bf16_f32 v57, v34, v35
  v_cvt_pk_bf16_f32 v58, v36, v37
  v_cvt_pk_bf16_f32 v59, v38, v39
  v_cmp_gt_u32 vcc, 1073741824, v70
  s_cbranch_vccz L_dup_51
  buffer_store_dwordx4 v[56:59], v70, s[16:19], 0 offen sc1
L_dup_51:
  buffer_store_dwordx4 v[56:59], v68, s[16:19], 0 offen sc1
  v_cvt_pk_bf16_f32 v60, v40, v41
  v_cvt_pk_bf16_f32 v61, v42, v43
  v_cvt_pk_bf16_f32 v62, v44, v45
  v_cvt_pk_bf16_f32 v63, v46, v47
  v_cmp_gt_u32 vcc, 1073741824, v71
  s_cbranch_vccz L_dup_52
  buffer_store_dwordx4 v[60:63], v71, s[16:19], 0 offen sc1
L_dup_52:
  buffer_store_dwordx4 v[60:63], v69, s[16:19], 0 offen sc1
  s_branch L_mid
L_vtile:
  v_and_b32_e64 v247, 3, v1
  v_bfe_u32 v248, v1, 4, 1
  v_lshl_or_b32 v247, v248, 2, v247
  v_bfe_u32 v248, v1, 2, 2
  v_lshl_or_b32 v248, v3, 3, v248
  v_bfe_u32 v249, v1, 3, 1
  v_lshlrev_b32 v249, 6, v249
  v_lshl_add_u32 v249, v247, 3, v249
  v_lshl_add_u32 v249, v248, 7, v249
  v_add_u32 v12, 98304, v249
  v_xor_b32 v13, 64, v12
  s_waitcnt lgkmcnt(0)
  s_barrier
  ds_read_b128 v[128:131], v8 offset:0
  ds_read_b64_tr_b16 v[96:97], v12 offset:0
  ds_read_b64_tr_b16 v[98:99], v12 offset:512
  ds_read_b64_tr_b16 v[48:49], v13 offset:0
  ds_read_b64_tr_b16 v[50:51], v13 offset:512
  ds_read_b128 v[132:135], v9 offset:0
  ds_read_b64_tr_b16 v[100:101], v12 offset:2048
  ds_read_b64_tr_b16 v[102:103], v12 offset:2560
  ds_read_b64_tr_b16 v[52:53], v13 offset:2048
  ds_read_b64_tr_b16 v[54:55], v13 offset:2560
  ds_read_b128 v[136:139], v10 offset:0
  ds_read_b64_tr_b16 v[104:105], v12 offset:4096
  ds_read_b64_tr_b16 v[106:107], v12 offset:4608
  ds_read_b64_tr_b16 v[56:57], v13 offset:4096
  ds_read_b64_tr_b16 v[58:59], v13 offset:4608
  ds_read_b128 v[140:143], v11 offset:0
  ds_read_b64_tr_b16 v[108:109], v12 offset:6144
  ds_read_b64_tr_b16 v[110:111], v12 offset:6656
  ds_read_b64_tr_b16 v[60:61], v13 offset:6144
  ds_read_b64_tr_b16 v[62:63], v13 offset:6656
  s_lshl_b32 s60, s45, 2
  s_add_u32 s60, s60, s47
  s_lshl_b32 s60, s60, 16
  s_lshl_b32 s61, s44, 11
  s_add_u32 s60, s60, s61
  s_add_u32 s60, s60, 8422400
  v_lshl_add_u32 v246, v1, 4, s60
  s_add_u32 s51, s51, 0x9e3779b0
  s_lshr_b32 s60, s46, 1
  s_lshl_b32 s61, s60, 2
  v_and_b32 v247, 3, v1
  v_or_b32_e64 v247, s61, v247
  v_bfe_u32 v248, v1, 2, 1
  v_bfe_u32 v240, v1, 4, 1
  v_lshl_or_b32 v248, v240, 1, v248
  v_bfe_u32 v241, v1, 3, 1
  v_lshl_or_b32 v248, v241, 3, v248
  v_xor_b32 v247, v247, v248
  v_bfe_u32 v248, v1, 2, 2
  v_lshl_or_b32 v248, v240, 2, v248
  v_lshl_or_b32 v248, v3, 4, v248
  v_lshlrev_b32 v247, 3, v247
  v_lshl_add_u32 v247, v248, 7, v247
  v_and_b32 v248, 15, v1
  s_and_b32 s61, s46, 1
  s_lshl_b32 s61, s61, 4
  v_add_u32 v248, s61, v248
  s_lshl3_add_u32 s61, s49, s46
  s_lshl4_add_u32 s61, s61, s45
  s_lshl_b32 s61, s61, 9
  s_add_u32 s61, s61, 5242880
  v_and_b32 v243, 15, v1
  v_lshl_or_b32 v243, v3, 4, v243
  v_lshl_or_b32 v243, v243, 1, v240
  v_lshl_add_u32 v243, v243, 3, s61
  v_lshlrev_b32 v248, 4, v248
  v_lshrrev_b32 v242, 4, v1
  v_lshl_add_u32 v242, v242, 9, v248
  v_add_u32 v242, 122880, v242
  v_add_u32 v240, 98304, v247
  v_add_u32 v241, 1024, v240
  v_xor_b32 v241, 32, v241
  s_waitcnt lgkmcnt(0)
  s_barrier
  s_nop 0
  v_mfma_f32_32x32x16_bf16 v[16:31], v[128:131], v[96:99], 0
  ds_read_b128 v[144:147], v8 offset:16384
  ds_read_b64_tr_b16 v[112:113], v12 offset:8192
  ds_read_b64_tr_b16 v[114:115], v12 offset:8704
  v_mfma_f32_32x32x16_bf16 v[32:47], v[128:131], v[48:51], 0
  ds_read_b64_tr_b16 v[80:81], v13 offset:8192
  ds_read_b64_tr_b16 v[82:83], v13 offset:8704
  ds_read_b128 v[148:151], v9 offset:16384
  v_mfma_f32_32x32x16_bf16 v[16:31], v[132:135], v[100:103], v[16:31]
  ds_read_b64_tr_b16 v[116:117], v12 offset:10240
  ds_read_b64_tr_b16 v[118:119], v12 offset:10752
  ds_read_b64_tr_b16 v[84:85], v13 offset:10240
  ds_read_b64_tr_b16 v[86:87], v13 offset:10752
  v_mfma_f32_32x32x16_bf16 v[32:47], v[132:135], v[52:55], v[32:47]
  ds_read_b128 v[152:155], v10 offset:16384
  ds_read_b64_tr_b16 v[120:121], v12 offset:12288
  ds_read_b64_tr_b16 v[122:123], v12 offset:12800
  v_mfma_f32_32x32x16_bf16 v[16:31], v[136:139], v[104:107], v[16:31]
  ds_read_b64_tr_b16 v[88:89], v13 offset:12288
  ds_read_b64_tr_b16 v[90:91], v13 offset:12800
  ds_read_b128 v[156:159], v11 offset:16384
  s_sub_u32 s60, s50, 7
  s_lshl_b32 s60, s60, 6
  s_add_u32 s60, s60, 0
  v_add_u32 v247, s60, v2
  v_mul_u32_u24 v248, 2341, v247
  v_lshrrev_b32 v248, 16, v248
  v_mul_u32_u24 v249, 28, v248
  v_sub_u32 v249, v247, v249
  s_lshl_b32 s61, s45, 2
  s_add_u32 s61, s61, s47
  s_lshl_b32 s61, s61, 12
  s_add_u32 s61, s61, 1050624
  v_lshlrev_b32 v248, 18, v248
  v_lshl_add_u32 v248, v249, 4, v248
  v_lshlrev_b32 v250, 9, v3
  v_add3_u32 v64, v248, v250, s61
  v_add_u32 v65, 1024, v64
  v_lshrrev_b32 v250, 2, v249
  v_min_u32 v250, 1, v250
  v_add_u32 v66, 448, v64
  v_lshl_or_b32 v66, v250, 30, v66
  v_add_u32 v67, 1024, v66
  v_min_u32 v249, 1, v249
  v_subrev_u32 v249, 1, v249
  v_and_b32 v72, 0x3f803f80, v249
  v_mov_b32 v73, v72
  v_mov_b32 v74, v72
  v_mov_b32_e64 v75, v72
  v_mfma_f32_32x32x16_bf16 v[32:47], v[136:139], v[56:59], v[32:47]
  ds_read_b64_tr_b16 v[124:125], v12 offset:14336
  ds_read_b64_tr_b16 v[126:127], v12 offset:14848
  ds_read_b64_tr_b16 v[92:93], v13 offset:14336
  ds_read_b64_tr_b16 v[94:95], v13 offset:14848
  v_mfma_f32_32x32x16_bf16 v[16:31], v[140:143], v[108:111], v[16:31]
  v_mfma_f32_32x32x16_bf16 v[32:47], v[140:143], v[60:63], v[32:47]
  s_waitcnt lgkmcnt(0)
  s_barrier
  v_mfma_f32_32x32x16_bf16 v[16:31], v[144:147], v[112:115], v[16:31]
  ds_read_b128 v[160:163], v8 offset:32768
  ds_read_b64_tr_b16 v[96:97], v12 offset:16384
  ds_read_b64_tr_b16 v[98:99], v12 offset:16896
  v_mfma_f32_32x32x16_bf16 v[32:47], v[144:147], v[80:83], v[32:47]
  ds_read_b64_tr_b16 v[48:49], v13 offset:16384
  ds_read_b64_tr_b16 v[50:51], v13 offset:16896
  ds_read_b128 v[164:167], v9 offset:32768
  v_mfma_f32_32x32x16_bf16 v[16:31], v[148:151], v[116:119], v[16:31]
  ds_read_b64_tr_b16 v[100:101], v12 offset:18432
  ds_read_b64_tr_b16 v[102:103], v12 offset:18944
  ds_read_b64_tr_b16 v[52:53], v13 offset:18432
  ds_read_b64_tr_b16 v[54:55], v13 offset:18944
  v_mfma_f32_32x32x16_bf16 v[32:47], v[148:151], v[84:87], v[32:47]
  ds_read_b128 v[168:171], v10 offset:32768
  ds_read_b64_tr_b16 v[104:105], v12 offset:20480
  ds_read_b64_tr_b16 v[106:107], v12 offset:20992
  v_mfma_f32_32x32x16_bf16 v[16:31], v[152:155], v[120:123], v[16:31]
  ds_read_b64_tr_b16 v[56:57], v13 offset:20480
  ds_read_b64_tr_b16 v[58:59], v13 offset:20992
  ds_read_b128 v[172:175], v11 offset:32768
  s_sub_u32 s60, s50, 7
  s_lshl_b32 s60, s60, 6
  s_add_u32 s60, s60, 32
  v_add_u32 v247, s60, v2
  v_mul_u32_u24 v248, 2341, v247
  v_lshrrev_b32 v248, 16, v248
  v_mul_u32_u24 v249, 28, v248
  v_sub_u32 v249, v247, v249
  s_lshl_b32 s61, s45, 2
  s_add_u32 s61, s61, s47
  s_lshl_b32 s61, s61, 12
  s_add_u32 s61, s61, 1050624
  v_lshlrev_b32 v248, 18, v248
  v_lshl_add_u32 v248, v249, 4, v248
  v_lshlrev_b32 v250, 9, v3
  v_add3_u32 v68, v248, v250, s61
  v_add_u32 v69, 1024, v68
  v_lshrrev_b32 v250, 2, v249
  v_min_u32 v250, 1, v250
  v_add_u32 v70, 448, v68
  v_lshl_or_b32 v70, v250, 30, v70
  v_add_u32 v71, 1024, v70
  v_min_u32 v249, 1, v249
  v_subrev_u32 v249, 1, v249
  v_and_b32 v76, 0x3f803f80, v249
  v_mov_b32 v77, v76
  v_mov_b32 v78, v76
  v_mov_b32_e64 v79, v76
  v_mfma_f32_32x32x16_bf16 v[32:47], v[152:155], v[88:91], v[32:47]
  ds_read_b64_tr_b16 v[108:109], v12 offset:22528
  ds_read_b64_tr_b16 v[110:111], v12 offset:23040
  ds_read_b64_tr_b16 v[60:61], v13 offset:22528
  ds_read_b64_tr_b16 v[62:63], v13 offset:23040
  v_mfma_f32_32x32x16_bf16 v[16:31], v[156:159], v[124:127], v[16:31]
  v_mfma_f32_32x32x16_bf16 v[32:47], v[156:159], v[92:95], v[32:47]
  s_waitcnt lgkmcnt(0)
  s_barrier
  v_mfma_f32_32x32x16_bf16 v[16:31], v[160:163], v[96:99], v[16:31]
  ds_read_b128 v[176:179], v8 offset:49152
  ds_read_b64_tr_b16 v[112:113], v12 offset:24576
  ds_read_b64_tr_b16 v[114:115], v12 offset:25088
  v_mfma_f32_32x32x16_bf16 v[32:47], v[160:163], v[48:51], v[32:47]
  ds_read_b64_tr_b16 v[80:81], v13 offset:24576
  ds_read_b64_tr_b16 v[82:83], v13 offset:25088
  ds_read_b128 v[180:183], v9 offset:49152
  v_mfma_f32_32x32x16_bf16 v[16:31], v[164:167], v[100:103], v[16:31]
  ds_read_b64_tr_b16 v[116:117], v12 offset:26624
  ds_read_b64_tr_b16 v[118:119], v12 offset:27136
  ds_read_b64_tr_b16 v[84:85], v13 offset:26624
  ds_read_b64_tr_b16 v[86:87], v13 offset:27136
  v_mfma_f32_32x32x16_bf16 v[32:47], v[164:167], v[52:55], v[32:47]
  ds_read_b128 v[184:187], v10 offset:49152
  ds_read_b64_tr_b16 v[120:121], v12 offset:28672
  ds_read_b64_tr_b16 v[122:123], v12 offset:29184
  v_mfma_f32_32x32x16_bf16 v[16:31], v[168:171], v[104:107], v[16:31]
  ds_read_b64_tr_b16 v[88:89], v13 offset:28672
  ds_read_b64_tr_b16 v[90:91], v13 offset:29184
  ds_read_b128 v[188:191], v11 offset:49152
  s_cmp_eq_u32 s44, 5
  s_cselect_b32 s62, 0, 33554432
  s_cmp_eq_u32 s44, 10
  s_cselect_b32 s18, 0, s62
  s_mov_b32 s16, s40
  s_mov_b32 s17, s41
  s_mov_b32 s19, 0x20000
  v_mfma_f32_32x32x16_bf16 v[32:47], v[168:171], v[56:59], v[32:47]
  ds_read_b64_tr_b16 v[124:125], v12 offset:30720
  ds_read_b64_tr_b16 v[126:127], v12 offset:31232
  ds_read_b64_tr_b16 v[92:93], v13 offset:30720
  ds_read_b64_tr_b16 v[94:95], v13 offset:31232
  v_mfma_f32_32x32x16_bf16 v[16:31], v[172:175], v[108:111], v[16:31]
  v_mfma_f32_32x32x16_bf16 v[32:47], v[172:175], v[60:63], v[32:47]
  s_waitcnt lgkmcnt(0)
  s_barrier
  s_nop 0
  v_mfma_f32_32x32x16_bf16 v[16:31], v[176:179], v[112:115], v[16:31]
  ds_read_b128 v[192:195], v8 offset:0
  ds_read_b64_tr_b16 v[96:97], v12 offset:32768
  ds_read_b64_tr_b16 v[98:99], v12 offset:33280
  v_mfma_f32_32x32x16_bf16 v[32:47], v[176:179], v[80:83], v[32:47]
  ds_read_b64_tr_b16 v[48:49], v13 offset:32768
  ds_read_b64_tr_b16 v[50:51], v13 offset:33280
  ds_read_b128 v[196:199], v9 offset:0
  v_mfma_f32_32x32x16_bf16 v[16:31], v[180:183], v[116:119], v[16:31]
  ds_read_b64_tr_b16 v[100:101], v12 offset:34816
  ds_read_b64_tr_b16 v[102:103], v12 offset:35328
  ds_read_b64_tr_b16 v[52:53], v13 offset:34816
  ds_read_b64_tr_b16 v[54:55], v13 offset:35328
  v_mfma_f32_32x32x16_bf16 v[32:47], v[180:183], v[84:87], v[32:47]
  ds_read_b128 v[200:203], v10 offset:0
  ds_read_b64_tr_b16 v[104:105], v12 offset:36864
  ds_read_b64_tr_b16 v[106:107], v12 offset:37376
  v_mfma_f32_32x32x16_bf16 v[16:31], v[184:187], v[120:123], v[16:31]
  ds_read_b64_tr_b16 v[56:57], v13 offset:36864
  ds_read_b64_tr_b16 v[58:59], v13 offset:37376
  ds_read_b128 v[204:207], v11 offset:0
  v_mfma_f32_32x32x16_bf16 v[32:47], v[184:187], v[88:91], v[32:47]
  ds_read_b64_tr_b16 v[108:109], v12 offset:38912
  ds_read_b64_tr_b16 v[110:111], v12 offset:39424
  ds_read_b64_tr_b16 v[60:61], v13 offset:38912
  ds_read_b64_tr_b16 v[62:63], v13 offset:39424
  v_mfma_f32_32x32x16_bf16 v[16:31], v[188:191], v[124:127], v[16:31]
  v_mfma_f32_32x32x16_bf16 v[32:47], v[188:191], v[92:95], v[32:47]
  s_waitcnt lgkmcnt(0)
  s_barrier
  v_mfma_f32_32x32x16_bf16 v[16:31], v[192:195], v[96:99], v[16:31]
  ds_read_b128 v[208:211], v8 offset:16384
  ds_read_b64_tr_b16 v[112:113], v12 offset:40960
  ds_read_b64_tr_b16 v[114:115], v12 offset:41472
  v_mfma_f32_32x32x16_bf16 v[32:47], v[192:195], v[48:51], v[32:47]
  ds_read_b64_tr_b16 v[80:81], v13 offset:40960
  ds_read_b64_tr_b16 v[82:83], v13 offset:41472
  ds_read_b128 v[212:215], v9 offset:16384
  v_mfma_f32_32x32x16_bf16 v[16:31], v[196:199], v[100:103], v[16:31]
  ds_read_b64_tr_b16 v[116:117], v12 offset:43008
  ds_read_b64_tr_b16 v[118:119], v12 offset:43520
  ds_read_b64_tr_b16 v[84:85], v13 offset:43008
  ds_read_b64_tr_b16 v[86:87], v13 offset:43520
  v_mfma_f32_32x32x16_bf16 v[32:47], v[196:199], v[52:55], v[32:47]
  ds_read_b128 v[216:219], v10 offset:16384
  ds_read_b64_tr_b16 v[120:121], v12 offset:45056
  ds_read_b64_tr_b16 v[122:123], v12 offset:45568
  v_mfma_f32_32x32x16_bf16 v[16:31], v[200:203], v[104:107], v[16:31]
  ds_read_b64_tr_b16 v[88:89], v13 offset:45056
  ds_read_b64_tr_b16 v[90:91], v13 offset:45568
  ds_read_b128 v[220:223], v11 offset:16384
  v_mfma_f32_32x32x16_bf16 v[32:47], v[200:203], v[56:59], v[32:47]
  ds_read_b64_tr_b16 v[124:125], v12 offset:47104
  ds_read_b64_tr_b16 v[126:127], v12 offset:47616
  ds_read_b64_tr_b16 v[92:93], v13 offset:47104
  ds_read_b64_tr_b16 v[94:95], v13 offset:47616
  v_mfma_f32_32x32x16_bf16 v[16:31], v[204:207], v[108:111], v[16:31]
  v_mfma_f32_32x32x16_bf16 v[32:47], v[204:207], v[60:63], v[32:47]
  s_waitcnt lgkmcnt(0)
  s_barrier
  v_mfma_f32_32x32x16_bf16 v[16:31], v[208:211], v[112:115], v[16:31]
  ds_read_b128 v[224:227], v8 offset:32768
  ds_read_b64_tr_b16 v[96:97], v12 offset:49152
  ds_read_b64_tr_b16 v[98:99], v12 offset:49664
  v_mfma_f32_32x32x16_bf16 v[32:47], v[208:211], v[80:83], v[32:47]
  ds_read_b64_tr_b16 v[48:49], v13 offset:49152
  ds_read_b64_tr_b16 v[50:51], v13 offset:49664
  ds_read_b128 v[228:231], v9 offset:32768
  v_mfma_f32_32x32x16_bf16 v[16:31], v[212:215], v[116:119], v[16:31]
  ds_read_b64_tr_b16 v[100:101], v12 offset:51200
  ds_read_b64_tr_b16 v[102:103], v12 offset:51712
  ds_read_b64_tr_b16 v[52:53], v13 offset:51200
  ds_read_b64_tr_b16 v[54:55], v13 offset:51712
  v_mfma_f32_32x32x16_bf16 v[32:47], v[212:215], v[84:87], v[32:47]
  ds_read_b128 v[232:235], v10 offset:32768
  ds_read_b64_tr_b16 v[104:105], v12 offset:53248
  ds_read_b64_tr_b16 v[106:107], v12 offset:53760
  v_mfma_f32_32x32x16_bf16 v[16:31], v[216:219], v[120:123], v[16:31]
  ds_read_b64_tr_b16 v[56:57], v13 offset:53248
  ds_read_b64_tr_b16 v[58:59], v13 offset:53760
  ds_read_b128 v[236:239], v11 offset:32768
  v_mfma_f32_32x32x16_bf16 v[32:47], v[216:219], v[88:91], v[32:47]
  ds_read_b64_tr_b16 v[108:109], v12 offset:55296
  ds_read_b64_tr_b16 v[110:111], v12 offset:55808
  ds_read_b64_tr_b16 v[60:61], v13 offset:55296
  ds_read_b64_tr_b16 v[62:63], v13 offset:55808
  v_mfma_f32_32x32x16_bf16 v[16:31], v[220:223], v[124:127], v[16:31]
  v_mfma_f32_32x32x16_bf16 v[32:47], v[220:223], v[92:95], v[32:47]
  s_waitcnt lgkmcnt(0)
  v_mfma_f32_32x32x16_bf16 v[16:31], v[224:227], v[96:99], v[16:31]
  v_mfma_f32_32x32x16_bf16 v[32:47], v[224:227], v[48:51], v[32:47]
  v_mfma_f32_32x32x16_bf16 v[16:31], v[228:231], v[100:103], v[16:31]
  v_mfma_f32_32x32x16_bf16 v[32:47], v[228:231], v[52:55], v[32:47]
  v_mfma_f32_32x32x16_bf16 v[16:31], v[232:235], v[104:107], v[16:31]
  v_mfma_f32_32x32x16_bf16 v[32:47], v[232:235], v[56:59], v[32:47]
  v_mfma_f32_32x32x16_bf16 v[16:31], v[236:239], v[108:111], v[16:31]
  v_mfma_f32_32x32x16_bf16 v[32:47], v[236:239], v[60:63], v[32:47]
  s_setprio 3
  v_cmp_gt_u32 vcc, 1073741824, v66
  s_cbranch_vccz L_dup_45
  buffer_store_dwordx4 v[72:75], v66, s[16:19], 0 offen sc1
L_dup_45:
  v_cmp_gt_u32 vcc, 1073741824, v67
  s_cbranch_vccz L_dup_46
  buffer_store_dwordx4 v[72:75], v67, s[16:19], 0 offen sc1
L_dup_46:
  v_cmp_gt_u32 vcc, 1073741824, v70
  s_cbranch_vccz L_dup_47
  buffer_store_dwordx4 v[76:79], v70, s[16:19], 0 offen sc1
L_dup_47:
  v_cmp_gt_u32 vcc, 1073741824, v71
  s_cbranch_vccz L_dup_48
  buffer_store_dwordx4 v[76:79], v71, s[16:19], 0 offen sc1
L_dup_48:
  s_nop 1
  s_nop 0
  v_cvt_pk_bf16_f32 v48, v16, v17
  v_cvt_pk_bf16_f32 v49, v18, v19
  v_cvt_pk_bf16_f32 v50, v20, v21
  v_cvt_pk_bf16_f32 v51, v22, v23
  buffer_store_dwordx4 v[48:51], v64, s[16:19], 0 offen sc1
  v_cvt_pk_bf16_f32 v52, v24, v25
  v_cvt_pk_bf16_f32 v53, v26, v27
  v_cvt_pk_bf16_f32 v54, v28, v29
  v_cvt_pk_bf16_f32 v55, v30, v31
  buffer_store_dwordx4 v[52:55], v65, s[16:19], 0 offen sc1
  v_cvt_pk_bf16_f32 v56, v32, v33
  v_cvt_pk_bf16_f32 v57, v34, v35
  v_cvt_pk_bf16_f32 v58, v36, v37
  v_cvt_pk_bf16_f32 v59, v38, v39
  buffer_store_dwordx4 v[56:59], v68, s[16:19], 0 offen sc1
  v_cvt_pk_bf16_f32 v60, v40, v41
  v_cvt_pk_bf16_f32 v61, v42, v43
  v_cvt_pk_bf16_f32 v62, v44, v45
  v_cvt_pk_bf16_f32 v63, v46, v47
  buffer_store_dwordx4 v[60:63], v69, s[16:19], 0 offen sc1
L_mid:
  s_waitcnt lgkmcnt(0)
  s_barrier
  v_and_b32_e64 v247, 1, v1
  v_bfe_u32 v248, v1, 1, 1
  v_lshl_or_b32 v247, v247, 1, v248
  v_bfe_u32 v248, v1, 4, 1
  v_lshl_or_b32 v247, v248, 2, v247
  v_bfe_u32 v248, v1, 2, 2
  v_lshl_or_b32 v248, v3, 3, v248
  v_lshrrev_b32 v249, 1, v247
  v_lshrrev_b32 v250, 2, v247
  v_and_b32 v249, v249, v250
  v_and_b32 v249, 1, v249
  v_xor_b32 v247, v247, v249
  v_lshlrev_b32 v247, 3, v247
  v_lshl_add_u32 v247, v248, 6, v247
  v_add_u32 v6, 65536, v247
  v_bfe_u32 v247, v1, 3, 1
  v_bfe_u32 v248, v1, 4, 1
  v_xor_b32 v247, v247, v248
  v_bfe_u32 v248, v1, 1, 2
  v_lshl_or_b32 v247, v247, 2, v248
  v_and_b32 v248, 1, v1
  v_lshlrev_b32 v248, 4, v248
  v_mov_b32 v249, 0x3f80
  v_lshlrev_b32 v248, v248, v249
  v_cmp_eq_u32 s[64:65], 0, v247
  s_nop 1
  v_cndmask_b32 v16, 0, v248, s[64:65]
  v_cmp_eq_u32 s[64:65], 1, v247
  s_nop 1
  v_cndmask_b32 v17, 0, v248, s[64:65]
  v_cmp_eq_u32 s[64:65], 2, v247
  s_nop 1
  v_cndmask_b32 v18, 0, v248, s[64:65]
  v_cmp_eq_u32 s[64:65], 3, v247
  s_nop 1
  v_cndmask_b32 v19, 0, v248, s[64:65]
  v_lshlrev_b32 v247, 4, v1
  v_add_u32 v247, 161792, v247
  ds_write_b128 v247, v[16:19]
  s_mov_b32 s20, s26
  s_mov_b32 s21, s27
  s_mov_b32 s22, 1204224
  s_mov_b32 s23, 0x20000
  s_mov_b32 s68, s32
  s_mov_b32 s69, s33
  s_mov_b32 s70, 1204224
  s_mov_b32 s71, 0x20000
  s_mul_i32 s60, s47, 43008
  v_lshrrev_b32 v247, 2, v1
  v_mul_u32_u24 v247, 2688, v247
  v_and_b32 v248, 3, v1
  v_lshl_add_u32 v247, v248, 4, v247
  v_lshrrev_b32 v249, 1, v248
  v_and_b32 v249, v249, v248
  v_lshlrev_b32 v249, 3, v249
  v_sub_u32 v247, v247, v249
  v_add_u32 v247, s60, v247
  s_mul_i32 s58, s49, 56
  s_mul_i32 s59, s53, 56
  s_mul_i32 s61, s44, 56
  s_add_u32 s58, s58, 896
  v_add_u32 v244, s58, v247
  v_add_u32 v245, s61, v247
  s_mul_i32 s84, s91, 1344
  v_add_u32 v244, 896, v244
  s_lshl_b32 s57, s47, 10
  s_add_u32 s57, s57, 65536
  s_barrier
  s_lshl_b32 s74, s46, 12
  s_lshl_b32 s60, s44, 18
  s_lshl_b32 s61, s47, 12
  s_add_u32 s60, s60, s61
  s_add_u32 s60, s60, 1179648
  v_lshl_add_u32 v12, v1, 4, s60
  v_lshlrev_b32 v8, 4, v1
  v_add_u32 v8, 16384, v8
  v_add_u32 v9, 0x10000, v8
  v_mov_b32 v10, 0xdddddddd
  s_mul_i32 s60, s44, 28
  s_add_u32 s61, s60, 27
  s_lshr_b32 s60, s60, 6
  s_lshr_b32 s61, s61, 6
  s_sub_u32 s61, s61, s60
  v_bfe_u32 v252, v1, 3, 1
  v_mul_u32_u24 v252, s61, v252
  v_bfe_u32 v253, v1, 4, 1
  v_mul_u32_u24 v253, 7, v253
  v_add3_u32 v252, v252, v253, s60
  s_lshr_b32 s60, s45, 1
  s_and_b32 s61, s45, 1
  s_lshl2_add_u32 s77, s61, s60
  v_add_u32 v253, s77, v1
  v_and_b32 v253, 7, v253
  v_lshl_add_u32 v252, v252, 4, v253
  s_lshl_b32 s60, s47, 6
  s_add_u32 s60, s60, 264192
  v_lshl_add_u32 v5, v252, 8, s60
  s_and_b32 s73, s77, 7
  s_lshl_b32 s73, s73, 14
  v_and_b32 v11, 1, v2
  v_bfe_u32 v247, v2, 2, 2
  v_lshl_or_b32 v11, v247, 1, v11
  v_bfe_u32 v247, v2, 1, 1
  v_lshl_or_b32 v11, v247, 3, v11
  v_xor_b32 v11, v11, v3
  v_lshlrev_b32 v11, 3, v11
  v_lshl_add_u32 v11, v2, 7, v11
  s_lshl_b32 s60, s47, 12
  s_add_u32 s60, s60, 98304
  v_add_u32 v11, s60, v11
  s_lshr_b32 s60, s44, 3
  s_lshl_b32 s60, s60, 1
  s_and_b32 s61, s46, 1
  s_add_u32 s60, s60, s61
  s_lshl2_add_u32 s55, s45, s60
  s_lshr_b32 s54, s46, 1
  s_and_b32 s60, s44, 7
  s_cmp_eq_u32 s60, 7
  s_cselect_b32 s10, 0, 401408
  s_cselect_b32 s6, 0, 401408
  s_mov_b32 s8, s30
  s_mov_b32 s9, s31
  s_mov_b32 s4, s34
  s_mov_b32 s5, s35
  s_mov_b32 s11, 0x20000
  s_mov_b32 s7, 0x20000
  s_lshl_b32 s60, s60, 7
  v_lshrrev_b32 v247, 3, v1
  v_and_b32 v248, 7, v1
  v_bfe_u32 v249, v1, 4, 1
  v_lshlrev_b32 v249, 2, v249
  v_xor_b32 v248, v248, v249
  v_mul_u32_u24 v247, 896, v247
  v_lshl_add_u32 v247, v248, 4, v247
  v_add_u32 v13, s60, v247
  s_mov_b32 s52, 4096
  s_lshl_b32 s60, s47, 11
  s_add_u32 s60, s60, 114688
  v_lshl_add_u32 v7, v1, 4, s60
  s_waitcnt vmcnt(0)
  s_lshl4_add_u32 s60, s50, s45
  s_lshl2_add_u32 s60, s60, s47
  s_lshl_b32 s60, s60, 6
  s_add_u32 s60, s60, 262144
  s_cmp_eq_u32 s18, 0
  s_cselect_b32 s60, 1073741824, s60
  v_mov_b32 v252, s60
  v_mov_b32 v253, s51
  s_mov_b64 exec, 1
  buffer_store_dword v253, v252, s[12:15], 0 offen sc1
  s_mov_b64 exec, -1
  s_setprio 0
  s_waitcnt lgkmcnt(0)
  s_barrier
  ds_read_b64_tr_b16 v[96:97], v6 offset:28672
  ds_read_b64_tr_b16 v[98:99], v6 offset:28928
  ds_read_b64_tr_b16 v[100:101], v6 offset:29696
  ds_read_b64_tr_b16 v[102:103], v6 offset:29952
  ds_read_b64_tr_b16 v[104:105], v6 offset:30720
  ds_read_b64_tr_b16 v[106:107], v6 offset:30976
  ds_read_b64_tr_b16 v[108:109], v6 offset:31744
  ds_read_b64_tr_b16 v[110:111], v6 offset:32000
  s_add_u32 m0, s57, 65536
  s_nop 0
  buffer_load_dwordx4 v245, s[68:71], s85 offen lds
  s_add_u32 m0, s57, 69632
  s_nop 0
  buffer_load_dwordx4 v244, s[20:23], s85 offen lds
  s_waitcnt lgkmcnt(0)
  s_nop 0
  v_mfma_f32_32x32x16_bf16 v[32:47], v[96:99], v[128:131], 0
  ds_read_b64_tr_b16 v[112:113], v6 offset:32768
  ds_read_b64_tr_b16 v[114:115], v6 offset:33024
  ds_read_b64_tr_b16 v[116:117], v6 offset:33792
  ds_read_b64_tr_b16 v[118:119], v6 offset:34048
  v_mfma_f32_32x32x16_bf16 v[32:47], v[100:103], v[132:135], v[32:47]
  ds_read_b64_tr_b16 v[120:121], v6 offset:34816
  ds_read_b64_tr_b16 v[122:123], v6 offset:35072
  ds_read_b64_tr_b16 v[124:125], v6 offset:35840
  ds_read_b64_tr_b16 v[126:127], v6 offset:36096
  v_mfma_f32_32x32x16_bf16 v[32:47], v[104:107], v[136:139], v[32:47]
  v_mfma_f32_32x32x16_bf16 v[32:47], v[108:111], v[140:143], v[32:47]
  s_add_u32 m0, s57, 73728
  s_nop 0
  buffer_load_dwordx4 v245, s[68:71], s86 offen lds
  s_add_u32 m0, s57, 77824
  s_nop 0
  buffer_load_dwordx4 v244, s[20:23], s86 offen lds
  s_waitcnt lgkmcnt(0)
  s_nop 0
  v_mfma_f32_32x32x16_bf16 v[32:47], v[112:115], v[144:147], v[32:47]
  ds_read_b64_tr_b16 v[96:97], v6 offset:36864
  ds_read_b64_tr_b16 v[98:99], v6 offset:37120
  ds_read_b64_tr_b16 v[100:101], v6 offset:37888
  ds_read_b64_tr_b16 v[102:103], v6 offset:38144
  v_mfma_f32_32x32x16_bf16 v[32:47], v[116:119], v[148:151], v[32:47]
  ds_read_b64_tr_b16 v[104:105], v6 offset:38912
  ds_read_b64_tr_b16 v[106:107], v6 offset:39168
  ds_read_b64_tr_b16 v[108:109], v6 offset:39936
  ds_read_b64_tr_b16 v[110:111], v6 offset:40192
  v_mfma_f32_32x32x16_bf16 v[32:47], v[120:123], v[152:155], v[32:47]
  v_mfma_f32_32x32x16_bf16 v[32:47], v[124:127], v[156:159], v[32:47]
  s_add_u32 m0, s57, 81920
  s_nop 0
  buffer_load_dwordx4 v245, s[68:71], s87 offen lds
  s_add_u32 m0, s57, 86016
  s_nop 0
  buffer_load_dwordx4 v244, s[20:23], s87 offen lds
  s_waitcnt lgkmcnt(0)
  s_barrier
  v_mfma_f32_32x32x16_bf16 v[32:47], v[96:99], v[160:163], v[32:47]
  ds_read_b64_tr_b16 v[112:113], v6 offset:40960
  ds_read_b64_tr_b16 v[114:115], v6 offset:41216
  ds_read_b64_tr_b16 v[116:117], v6 offset:41984
  ds_read_b64_tr_b16 v[118:119], v6 offset:42240
  v_mfma_f32_32x32x16_bf16 v[32:47], v[100:103], v[164:167], v[32:47]
  ds_read_b64_tr_b16 v[120:121], v6 offset:43008
  ds_read_b64_tr_b16 v[122:123], v6 offset:43264
  ds_read_b64_tr_b16 v[124:125], v6 offset:44032
  ds_read_b64_tr_b16 v[126:127], v6 offset:44288
  v_mfma_f32_32x32x16_bf16 v[32:47], v[104:107], v[168:171], v[32:47]
  v_mfma_f32_32x32x16_bf16 v[32:47], v[108:111], v[172:175], v[32:47]
  s_add_u32 m0, s57, 0
  s_nop 0
  buffer_load_dwordx4 v245, s[68:71], s88 offen lds
  s_add_u32 m0, s57, 4096
  s_nop 0
  buffer_load_dwordx4 v244, s[20:23], s88 offen lds
  s_waitcnt lgkmcnt(0)
  v_mfma_f32_32x32x16_bf16 v[32:47], v[112:115], v[176:179], v[32:47]
  ds_read_b64_tr_b16 v[96:97], v6 offset:45056
  ds_read_b64_tr_b16 v[98:99], v6 offset:45312
  ds_read_b64_tr_b16 v[100:101], v6 offset:46080
  ds_read_b64_tr_b16 v[102:103], v6 offset:46336
  v_mov_b32 v160, 0
  v_mov_b32 v161, 0
  v_mov_b32 v162, 0
  v_mov_b32 v163, 0
  v_mfma_f32_32x32x16_bf16 v[32:47], v[116:119], v[180:183], v[32:47]
  ds_read_b64_tr_b16 v[104:105], v6 offset:47104
  ds_read_b64_tr_b16 v[106:107], v6 offset:47360
  ds_read_b64_tr_b16 v[108:109], v6 offset:48128
  ds_read_b64_tr_b16 v[110:111], v6 offset:48384
  v_mov_b32 v164, 0
  v_mov_b32 v165, 0
  v_mov_b32 v166, 0
  v_mov_b32 v167, 0
  v_mfma_f32_32x32x16_bf16 v[32:47], v[120:123], v[184:187], v[32:47]
  v_mov_b32 v168, 0
  v_mov_b32 v169, 0
  v_mov_b32 v170, 0
  v_mov_b32 v171, 0
  v_mfma_f32_32x32x16_bf16 v[32:47], v[124:127], v[188:191], v[32:47]
  v_mov_b32 v172, 0
  v_mov_b32 v173, 0
  v_mov_b32 v174, 0
  v_mov_b32 v175, 0
  s_add_u32 m0, s57, 8192
  s_nop 0
  buffer_load_dwordx4 v245, s[68:71], s89 offen lds
  s_add_u32 m0, s57, 12288
  s_nop 0
  buffer_load_dwordx4 v244, s[20:23], s89 offen lds
  s_waitcnt lgkmcnt(0)
  s_nop 0
  v_mfma_f32_32x32x16_bf16 v[32:47], v[96:99], v[192:195], v[32:47]
  ds_read_b64_tr_b16 v[112:113], v6 offset:49152
  ds_read_b64_tr_b16 v[114:115], v6 offset:49408
  ds_read_b64_tr_b16 v[116:117], v6 offset:50176
  ds_read_b64_tr_b16 v[118:119], v6 offset:50432
  v_mfma_f32_32x32x16_bf16 v[32:47], v[100:103], v[196:199], v[32:47]
  ds_read_b64_tr_b16 v[120:121], v6 offset:51200
  ds_read_b64_tr_b16 v[122:123], v6 offset:51456
  ds_read_b64_tr_b16 v[124:125], v6 offset:52224
  ds_read_b64_tr_b16 v[126:127], v6 offset:52480
  v_mfma_f32_32x32x16_bf16 v[32:47], v[104:107], v[200:203], v[32:47]
  v_mfma_f32_32x32x16_bf16 v[32:47], v[108:111], v[204:207], v[32:47]
  s_add_u32 m0, s57, 16384
  s_nop 0
  buffer_load_dwordx4 v245, s[68:71], s90 offen lds
  s_add_u32 m0, s57, 20480
  s_nop 0
  buffer_load_dwordx4 v244, s[20:23], s90 offen lds
  s_waitcnt lgkmcnt(0)
  s_nop 0
  v_mfma_f32_32x32x16_bf16 v[32:47], v[112:115], v[208:211], v[32:47]
  ds_read_b64_tr_b16 v[96:97], v6 offset:53248
  ds_read_b64_tr_b16 v[98:99], v6 offset:53504
  ds_read_b64_tr_b16 v[100:101], v6 offset:54272
  ds_read_b64_tr_b16 v[102:103], v6 offset:54528
  v_mfma_f32_32x32x16_bf16 v[32:47], v[116:119], v[212:215], v[32:47]
  ds_read_b64_tr_b16 v[104:105], v6 offset:55296
  ds_read_b64_tr_b16 v[106:107], v6 offset:55552
  ds_read_b64_tr_b16 v[108:109], v6 offset:56320
  ds_read_b64_tr_b16 v[110:111], v6 offset:56576
  v_mfma_f32_32x32x16_bf16 v[32:47], v[120:123], v[216:219], v[32:47]
  v_and_b32_e64 v247, 3, v1
  v_bfe_u32 v248, v1, 4, 1
  v_lshl_or_b32 v247, v248, 2, v247
  v_bfe_u32 v248, v1, 2, 2
  v_lshl_or_b32 v248, v3, 3, v248
  v_lshlrev_b32_e64 v247, 3, v247
  v_lshl_add_u32 v247, v248, 6, v247
  v_add_u32 v247, 155648, v247
  ds_read_b64_tr_b16 v[80:81], v247 offset:0
  ds_read_b64_tr_b16 v[82:83], v247 offset:256
  ds_read_b64_tr_b16 v[84:85], v247 offset:1024
  ds_read_b64_tr_b16 v[86:87], v247 offset:1280
  s_mov_b32 s80, 0x3fb8aa3b
  v_mfma_f32_32x32x16_bf16 v[32:47], v[124:127], v[220:223], v[32:47]
  s_waitcnt vmcnt(10)
  s_waitcnt lgkmcnt(0)
  s_barrier
  v_mfma_f32_32x32x16_bf16 v[32:47], v[96:99], v[224:227], v[32:47]
  v_mfma_f32_32x32x16_bf16 v[32:47], v[100:103], v[228:231], v[32:47]
  v_mfma_f32_32x32x16_bf16 v[32:47], v[104:107], v[232:235], v[32:47]
  v_mfma_f32_32x32x16_bf16 v[32:47], v[108:111], v[236:239], v[32:47]
  s_nop 11
  v_cvt_pk_bf16_f32 v88, v32, v33
  v_cvt_pk_bf16_f32 v89, v34, v35
  v_cvt_pk_bf16_f32 v90, v36, v37
  v_cvt_pk_bf16_f32 v91, v38, v39
  v_cvt_pk_bf16_f32 v92, v40, v41
  v_cvt_pk_bf16_f32 v93, v42, v43
  v_cvt_pk_bf16_f32 v94, v44, v45
  v_cvt_pk_bf16_f32 v95, v46, v47
  v_mfma_f32_32x32x16_bf16 v[48:63], v[80:83], v[88:91], 0
  s_nop 0
  v_mfma_f32_32x32x16_bf16 v[48:63], v[84:87], v[92:95], v[48:63]
  s_nop 11
  v_cvt_pk_bf16_f32 v64, v48, v49
  v_cvt_pk_bf16_f32 v65, v50, v51
  v_cvt_pk_bf16_f32 v66, v52, v53
  v_cvt_pk_bf16_f32 v67, v54, v55
  v_cvt_pk_bf16_f32 v68, v56, v57
  v_cvt_pk_bf16_f32 v69, v58, v59
  v_cvt_pk_bf16_f32 v70, v60, v61
  v_cvt_pk_bf16_f32 v71, v62, v63
  v_lshlrev_b32 v48, 16, v64
  v_and_b32 v49, 0xffff0000, v64
  v_lshlrev_b32 v50, 16, v65
  v_and_b32 v51, 0xffff0000, v65
  v_lshlrev_b32 v52, 16, v66
  v_and_b32 v53, 0xffff0000, v66
  v_lshlrev_b32 v54, 16, v67
  v_and_b32 v55, 0xffff0000, v67
  v_lshlrev_b32 v56, 16, v68
  v_and_b32 v57, 0xffff0000, v68
  v_lshlrev_b32 v58, 16, v69
  v_and_b32 v59, 0xffff0000, v69
  v_lshlrev_b32 v60, 16, v70
  v_and_b32 v61, 0xffff0000, v70
  v_lshlrev_b32 v62, 16, v71
  v_and_b32 v63, 0xffff0000, v71
  v_max3_f32 v247, v48, v49, v50
  v_max3_f32 v248, -v48, -v49, -v50
  v_max3_f32 v247, v247, v51, v52
  v_max3_f32 v248, v248, -v51, -v52
  v_max3_f32 v247, v247, v53, v54
  v_max3_f32 v248, v248, -v53, -v54
  v_max3_f32 v247, v247, v55, v56
  v_max3_f32 v248, v248, -v55, -v56
  v_max3_f32 v247, v247, v57, v58
  v_max3_f32 v248, v248, -v57, -v58
  v_max3_f32 v247, v247, v59, v60
  v_max3_f32 v248, v248, -v59, -v60
  v_max3_f32 v247, v247, v61, v62
  v_max3_f32 v248, v248, -v61, -v62
  v_max_f32 v247, v247, v63
  v_max_f32_e64 v248, v248, -v63
  v_sub_u32 v249, 0, v3
  v_and_b32 v249, 0x7f800000, v249
  v_permlane32_swap_b32 v247, v248
  v_max_f32 v247, v247, v248
  v_mul_f32 v248, s80, v247
  v_mul_f32 v250, s80, v247
  s_nop 1
  v_permlane32_swap_b32 v248, v250
  v_fma_f32 v64, v48, s80, -v248
  v_fma_f32 v65, v49, s80, -v248
  v_fma_f32 v80, -v48, s80, -v250
  v_fma_f32 v81, -v49, s80, -v250
  v_fma_f32 v66, v50, s80, -v248
  v_fma_f32 v67, v51, s80, -v248
  v_fma_f32 v82, -v50, s80, -v250
  v_fma_f32 v83, -v51, s80, -v250
  v_fma_f32 v68, v52, s80, -v248
  v_fma_f32 v69, v53, s80, -v248
  v_fma_f32 v84, -v52, s80, -v250
  v_fma_f32 v85, -v53, s80, -v250
  v_fma_f32 v70, v54, s80, -v248
  v_fma_f32 v71, v55, s80, -v248
  v_fma_f32 v86, -v54, s80, -v250
  v_fma_f32 v87, -v55, s80, -v250
  buffer_load_dword v4, v5, s[12:15], 0 offen sc1
  s_waitcnt vmcnt(7)
  s_waitcnt lgkmcnt(0)
  s_barrier
  s_nop 0
  v_fma_f32 v72, v56, s80, -v248
  v_fma_f32 v73, v57, s80, -v248
  v_fma_f32 v88, -v56, s80, -v250
  v_fma_f32 v89, -v57, s80, -v250
  v_fma_f32 v74, v58, s80, -v248
  v_fma_f32 v75, v59, s80, -v248
  v_fma_f32 v90, -v58, s80, -v250
  v_fma_f32 v91, -v59, s80, -v250
  v_add_f32 v248, v248, v249
  v_add_f32 v250, v250, v249
  v_fma_f32 v76, v60, s80, -v248
  v_fma_f32 v77, v61, s80, -v248
  v_fma_f32 v92, -v60, s80, -v250
  v_fma_f32 v93, -v61, s80, -v250
  v_fma_f32 v78, v62, s80, -v248
  v_fma_f32 v79, v63, s80, -v248
  v_fma_f32 v94, -v62, s80, -v250
  v_fma_f32 v95, -v63, s80, -v250
  v_exp_f32 v64, v64
  v_exp_f32 v65, v65
  v_exp_f32 v66, v66
  v_exp_f32 v67, v67
  v_exp_f32 v68, v68
  v_exp_f32 v69, v69
  v_exp_f32 v70, v70
  v_exp_f32 v71, v71
  v_exp_f32 v72, v72
  v_exp_f32 v73, v73
  v_exp_f32 v74, v74
  v_exp_f32 v75, v75
  v_exp_f32 v76, v76
  v_exp_f32 v77, v77
  v_exp_f32 v78, v78
  v_exp_f32 v79, v79
  v_exp_f32 v80, v80
  v_exp_f32 v81, v81
  v_exp_f32 v82, v82
  v_exp_f32 v83, v83
  v_exp_f32 v84, v84
  v_exp_f32 v85, v85
  v_exp_f32 v86, v86
  v_exp_f32 v87, v87
  v_exp_f32 v88, v88
  v_exp_f32 v89, v89
  v_exp_f32 v90, v90
  s_waitcnt vmcnt(0)
  v_cmp_eq_u32 vcc, s51, v4
  s_nop 0
  s_lshr_b32 s76, vcc_lo, 16
  s_and_b32 s76, s76, vcc_lo
  s_lshr_b32 s58, s76, 8
  s_and_b32 s76, s76, s58
  s_and_b32 s76, s76, 0xff
  s_bitcmp1_b32 s76, 0
  s_cbranch_scc0 L_kp_53
L_kpd_54:
  s_add_u32 m0, s74, 0
  s_nop 0
  buffer_load_dwordx4 v12, s[12:15], s73 offen offset:0 sc1 lds
  s_add_u32 m0, s74, 0
  s_nop 0
  buffer_load_dwordx4 v12, s[12:15], s73 offen offset:1024 sc1 lds
  s_waitcnt lgkmcnt(0)
  s_barrier
  v_exp_f32 v91, v91
  v_exp_f32 v92, v92
  v_exp_f32 v93, v93
  v_exp_f32 v94, v94
  v_exp_f32 v95, v95
  v_add_f32 v248, v64, v66
  v_add_f32 v249, v65, v67
  v_add_f32 v250, v80, v82
  v_add_f32 v251, v81, v83
  v_add_f32 v248, v248, v68
  v_add_f32 v249, v249, v69
  v_add_f32 v250, v250, v84
  v_add_f32 v251, v251, v85
  v_add_f32 v248, v248, v70
  v_add_f32 v249, v249, v71
  v_add_f32 v250, v250, v86
  v_add_f32 v251, v251, v87
  v_add_f32 v248, v248, v72
  v_add_f32 v249, v249, v73
  v_add_f32 v250, v250, v88
  v_add_f32 v251, v251, v89
  v_add_f32 v248, v248, v74
  v_add_f32 v249, v249, v75
  v_add_f32 v250, v250, v90
  v_add_f32 v251, v251, v91
  v_add_f32 v248, v248, v76
  v_add_f32 v249, v249, v77
  v_add_f32 v250, v250, v92
  v_add_f32 v251, v251, v93
  v_add_f32 v248, v248, v78
  v_add_f32 v249, v249, v79
  v_add_f32 v250, v250, v94
  v_add_f32 v251, v251, v95
  s_add_u32 m0, s74, 0
  s_nop 0
  buffer_load_dwordx4 v12, s[12:15], s73 offen offset:2048 sc1 lds
  s_add_u32 m0, s74, 0
  s_nop 0
  buffer_load_dwordx4 v12, s[12:15], s73 offen offset:3072 sc1 lds
  s_add_u32 s73, s73, 16384
  s_and_b32 s73, s73, 0x1ffff
  v_add_f32 v248, v248, v249
  v_add_f32 v250, v250, v251
  s_nop 1
  v_permlane32_swap_b32 v248, v250
  v_add_f32 v248, v248, v250
  v_rcp_f32 v248, v248
  s_nop 0
  v_mov_b32 v250, v248
  s_nop 1
  v_permlane32_swap_b32 v248, v250
  v_mul_f32 v64, v64, v248
  v_mul_f32 v65, v65, v248
  v_mul_f32 v80, v80, v250
  v_mul_f32 v81, v81, v250
  v_mul_f32 v66, v66, v248
  v_mul_f32 v67, v67, v248
  v_mul_f32 v82, v82, v250
  v_mul_f32 v83, v83, v250
  v_mul_f32 v68, v68, v248
  v_mul_f32 v69, v69, v248
  v_mul_f32 v84, v84, v250
  v_mul_f32 v85, v85, v250
  v_mul_f32 v70, v70, v248
  v_mul_f32 v71, v71, v248
  v_mul_f32 v86, v86, v250
  v_mul_f32 v87, v87, v250
  v_mul_f32 v72, v72, v248
  v_mul_f32 v73, v73, v248
  v_mul_f32 v88, v88, v250
  v_mul_f32 v89, v89, v250
  v_mul_f32 v74, v74, v248
  v_mul_f32 v75, v75, v248
  v_mul_f32 v90, v90, v250
  v_mul_f32 v91, v91, v250
  v_mul_f32 v76, v76, v248
  v_mul_f32 v77, v77, v248
  s_waitcnt lgkmcnt(0)
  s_barrier
  v_mul_f32 v92, v92, v250
  v_mul_f32 v93, v93, v250
  v_mul_f32 v78, v78, v248
  v_mul_f32 v79, v79, v248
  v_mul_f32 v94, v94, v250
  v_mul_f32_e64 v95, v95, v250
  v_cvt_pk_bf16_f32 v32, v64, v65
  v_cvt_pk_bf16_f32 v40, v80, v81
  v_cvt_pk_bf16_f32 v33, v66, v67
  v_cvt_pk_bf16_f32 v41, v82, v83
  v_cvt_pk_bf16_f32 v34, v68, v69
  v_cvt_pk_bf16_f32 v42, v84, v85
  v_cvt_pk_bf16_f32 v35, v70, v71
  v_cvt_pk_bf16_f32 v43, v86, v87
  v_cvt_pk_bf16_f32 v36, v72, v73
  v_cvt_pk_bf16_f32 v44, v88, v89
  v_cvt_pk_bf16_f32 v37, v74, v75
  v_cvt_pk_bf16_f32 v45, v90, v91
  v_cvt_pk_bf16_f32 v38, v76, v77
  v_cvt_pk_bf16_f32 v46, v92, v93
  v_cvt_pk_bf16_f32 v39, v78, v79
  v_cvt_pk_bf16_f32 v47, v94, v95
  ds_write_b64 v11, v[32:33]
  v_xor_b32 v247, 16, v11
  ds_write_b64 v247, v[34:35]
  v_xor_b32 v247, 32, v11
  ds_write_b64 v247, v[36:37]
  v_xor_b32 v247, 48, v11
  ds_write_b64 v247, v[38:39]
  v_xor_b32 v247, 64, v11
  ds_write_b64 v247, v[40:41]
  v_xor_b32 v247, 80, v11
  ds_write_b64 v247, v[42:43]
  v_xor_b32 v247, 96, v11
  ds_write_b64 v247, v[44:45]
  v_xor_b32 v247, 112, v11
  ds_write_b64 v247, v[46:47]
  v_lshrrev_b32 v247, 2, v7
  v_and_b32 v247, 0x7fc, v247
  v_add_u32 v247, 159744, v247
  s_waitcnt vmcnt(0) lgkmcnt(0)
  s_barrier
  s_nop 0
  ds_read_b128 v[128:131], v7
  ds_read_b128 v[132:135], v7 offset:1024
  ds_read_b32 v15, v247
  ds_read_b128 v[136:139], v8 offset:0
  ds_read_b128 v[140:143], v8 offset:1024
  ds_read_b128 v[144:147], v8 offset:2048
  ds_read_b128 v[112:115], v8 offset:3072
  ds_read_b128 v[148:151], v8 offset:6144
  ds_read_b128 v[116:119], v8 offset:7168
  s_waitcnt lgkmcnt(4)
  v_mfma_f32_32x32x16_bf16 v[192:207], v[136:139], v[128:131], 0
  ds_read_b128 v[136:139], v8 offset:4096
  v_mfma_f32_32x32x16_bf16 v[192:207], v[140:143], v[132:135], v[192:207]
  ds_read_b128 v[140:143], v8 offset:5120
  s_bitcmp1_b32 s76, 1
  s_cbranch_scc0 L_kp_55
L_kpd_56:
  s_add_u32 m0, s74, 32768
  s_nop 0
  buffer_load_dwordx4 v12, s[12:15], s73 offen offset:0 sc1 lds
  s_add_u32 m0, s74, 32768
  s_nop 0
  buffer_load_dwordx4 v12, s[12:15], s73 offen offset:1024 sc1 lds
  s_nop 2
  v_max3_f32 v11, v192, v193, v194
  v_max3_f32 v11, v11, v195, v196
  v_max3_f32 v11, v11, v197, v198
  v_max3_f32 v11, v11, v199, v200
  v_max3_f32 v11, v11, v201, v202
  v_max3_f32 v11, v11, v203, v204
  v_max3_f32 v11, v11, v205, v206
  v_max_f32 v11, v11, v207
  v_mov_b32 v247, v11
  s_nop 1
  v_permlane32_swap_b32 v11, v247
  v_max_f32 v11, v11, v247
  v_sub_f32 v176, 0, v11
  v_mov_b32 v177, v176
  v_mov_b32 v178, v176
  v_mov_b32 v179, v176
  v_mov_b32 v180, v176
  v_mov_b32 v181, v176
  v_mov_b32 v182, v176
  v_mov_b32 v183, v176
  v_mov_b32 v184, v176
  v_mov_b32 v185, v176
  v_mov_b32 v186, v176
  v_mov_b32 v187, v176
  v_mov_b32 v188, v176
  v_mov_b32 v189, v176
  v_mov_b32 v190, v176
  v_mov_b32 v191, v176
  v_add_f32 v192, v192, v176
  v_add_f32 v193, v193, v177
  v_add_f32 v194, v194, v176
  v_add_f32 v195, v195, v177
  v_add_f32 v196, v196, v176
  v_add_f32 v197, v197, v177
  v_add_f32 v198, v198, v176
  v_add_f32 v199, v199, v177
  v_add_f32 v200, v200, v176
  v_add_f32 v201, v201, v177
  v_add_f32 v202, v202, v176
  v_add_f32 v203, v203, v177
  v_add_f32 v204, v204, v176
  v_add_f32 v205, v205, v177
  v_add_f32 v206, v206, v176
  v_add_f32 v207, v207, v177
  v_exp_f32 v192, v192
  v_exp_f32 v193, v193
  v_exp_f32 v194, v194
  v_exp_f32 v195, v195
  v_exp_f32 v196, v196
  s_waitcnt lgkmcnt(0)
  s_setprio 1
  v_mfma_f32_32x32x16_bf16 v[208:223], v[136:139], v[128:131], v[176:191]
  ds_read_b128 v[136:139], v8 offset:8192
  s_add_u32 m0, s74, 32768
  s_nop 0
  buffer_load_dwordx4 v12, s[12:15], s73 offen offset:2048 sc1 lds
  v_exp_f32 v197, v197
  v_exp_f32 v198, v198
  v_exp_f32 v199, v199
  v_mfma_f32_32x32x16_bf16 v[208:223], v[140:143], v[132:135], v[208:223]
  ds_read_b128 v[140:143], v8 offset:9216
  v_exp_f32 v200, v200
  v_exp_f32 v201, v201
  v_exp_f32 v202, v202
  v_exp_f32 v203, v203
  v_exp_f32 v204, v204
  v_smfmac_f32_32x32x32_bf16 v[160:175], v[144:147], v[192:199], v10
  ds_read_b128 v[144:147], v8 offset:10240
  ds_read_b128 v[120:123], v8 offset:11264
  s_add_u32 m0, s74, 32768
  s_nop 0
  buffer_load_dwordx4 v12, s[12:15], s73 offen offset:3072 sc1 lds
  s_add_u32 s73, s73, 16384
  s_and_b32 s73, s73, 0x1ffff
  v_exp_f32 v205, v205
  v_exp_f32 v206, v206
  v_exp_f32_e64 v207, v207
  ds_read_b64_tr_b16 v[64:65], v240 offset:0
  ds_read_b64_tr_b16 v[66:67], v241 offset:0
  ds_read_b128 v[80:83], v242 offset:0
  ds_read_b64_tr_b16 v[68:69], v240 offset:4096
  ds_read_b64_tr_b16 v[70:71], v241 offset:4096
  ds_read_b128 v[84:87], v242 offset:2048
  ds_read_b64_tr_b16 v[72:73], v240 offset:8192
  ds_read_b64_tr_b16 v[74:75], v241 offset:8192
  ds_read_b128 v[88:91], v242 offset:4096
  ds_read_b64_tr_b16 v[76:77], v240 offset:12288
  s_waitcnt lgkmcnt(8)
  ds_read_b64_tr_b16 v[78:79], v241 offset:12288
  ds_read_b128 v[92:95], v242 offset:6144
  v_exp_f32 v208, v208
  v_exp_f32 v209, v209
  v_smfmac_f32_32x32x32_bf16 v[160:175], v[112:115], v[200:207], v10
  v_exp_f32 v210, v210
  v_exp_f32 v211, v211
  v_exp_f32 v212, v212
  s_setprio 0
  v_mfma_f32_32x32x16_bf16 v[192:207], v[136:139], v[128:131], v[176:191]
  ds_read_b128 v[136:139], v8 offset:12288
  s_bitcmp1_b32 s76, 2
  s_cbranch_scc0 L_kp_57
L_kpd_58:
  s_add_u32 m0, s74, 65536
  s_nop 0
  buffer_load_dwordx4 v12, s[12:15], s73 offen offset:0 sc1 lds
  v_exp_f32 v213, v213
  v_exp_f32 v214, v214
  v_exp_f32 v215, v215
  v_mfma_f32_32x32x16_bf16 v[192:207], v[140:143], v[132:135], v[192:207]
  ds_read_b128 v[140:143], v8 offset:13312
  v_exp_f32 v216, v216
  v_exp_f32 v217, v217
  v_exp_f32 v218, v218
  v_exp_f32 v219, v219
  v_exp_f32 v220, v220
  v_smfmac_f32_32x32x32_bf16 v[160:175], v[148:151], v[208:215], v10
  ds_read_b128 v[148:151], v8 offset:14336
  ds_read_b128 v[112:115], v8 offset:15360
  s_add_u32 m0, s74, 65536
  s_nop 0
  buffer_load_dwordx4 v12, s[12:15], s73 offen offset:1024 sc1 lds
  v_exp_f32 v221, v221
  v_exp_f32 v222, v222
  v_exp_f32 v223, v223
  s_waitcnt lgkmcnt(4)
  buffer_load_dword v4, v5, s[12:15], 0 offen sc1
  v_exp_f32 v192, v192
  v_mfma_f32_16x16x32_bf16 v[48:51], v[64:67], v[80:83], 0
  v_exp_f32 v193, v193
  v_smfmac_f32_32x32x32_bf16 v[160:175], v[116:119], v[216:223], v10
  v_exp_f32 v194, v194
  v_exp_f32 v195, v195
  v_mfma_f32_16x16x32_bf16 v[48:51], v[68:71], v[84:87], v[48:51]
  v_exp_f32 v196, v196
  s_waitcnt vmcnt(3) lgkmcnt(0)
  s_barrier
  s_setprio 3
  v_mfma_f32_32x32x16_bf16 v[208:223], v[136:139], v[128:131], v[176:191]
  ds_read_b128 v[136:139], v8 offset:32768
  s_add_u32 m0, s74, 65536
  s_nop 0
  buffer_load_dwordx4 v12, s[12:15], s73 offen offset:2048 sc1 lds
  v_exp_f32 v197, v197
  v_exp_f32 v198, v198
  v_mfma_f32_16x16x32_bf16 v[48:51], v[72:75], v[88:91], v[48:51]
  v_exp_f32 v199, v199
  v_mfma_f32_32x32x16_bf16 v[208:223], v[140:143], v[132:135], v[208:223]
  ds_read_b128 v[140:143], v8 offset:33792
  v_exp_f32 v200, v200
  v_exp_f32 v201, v201
  v_mfma_f32_16x16x32_bf16 v[48:51], v[76:79], v[92:95], v[48:51]
  v_exp_f32 v202, v202
  v_exp_f32 v203, v203
  v_exp_f32 v204, v204
  v_smfmac_f32_32x32x32_bf16 v[160:175], v[144:147], v[192:199], v10
  ds_read_b128 v[144:147], v8 offset:34816
  ds_read_b128 v[116:119], v8 offset:35840
  s_add_u32 m0, s74, 65536
  s_nop 0
  buffer_load_dwordx4 v12, s[12:15], s73 offen offset:3072 sc1 lds
  s_add_u32 s73, s73, 16384
  s_and_b32 s73, s73, 0x1ffff
  v_exp_f32 v205, v205
  v_exp_f32 v206, v206
  v_exp_f32 v207, v207
  v_cvt_pk_bf16_f32 v52, v48, v49
  v_cvt_pk_bf16_f32 v53, v50, v51
  buffer_store_dwordx2 v[52:53], v243, s[12:15], 0 offen sc1
  v_exp_f32 v208, v208
  v_exp_f32 v209, v209
  v_smfmac_f32_32x32x32_bf16 v[160:175], v[120:123], v[200:207], v10
  v_exp_f32 v210, v210
  v_exp_f32 v211, v211
  v_exp_f32 v212, v212
  s_waitcnt lgkmcnt(2)
  s_setprio 2
  v_mfma_f32_32x32x16_bf16 v[192:207], v[136:139], v[128:131], v[176:191]
  ds_read_b128 v[136:139], v8 offset:36864
  s_bitcmp1_b32 s76, 3
  s_cbranch_scc0 L_kp_59
L_kpd_60:
  s_add_u32 m0, s74, 0
  s_nop 0
  buffer_load_dwordx4 v12, s[12:15], s73 offen offset:0 sc1 lds
  v_exp_f32 v213, v213
  v_exp_f32 v214, v214
  v_exp_f32 v215, v215
  v_mfma_f32_32x32x16_bf16 v[192:207], v[140:143], v[132:135], v[192:207]
  ds_read_b128 v[140:143], v8 offset:37888
  v_exp_f32 v216, v216
  v_exp_f32 v217, v217
  v_exp_f32 v218, v218
  v_exp_f32 v219, v219
  v_exp_f32 v220, v220
  v_smfmac_f32_32x32x32_bf16 v[160:175], v[148:151], v[208:215], v10
  ds_read_b128 v[148:151], v8 offset:38912
  ds_read_b128 v[120:123], v8 offset:39936
  s_add_u32 m0, s74, 0
  s_nop 0
  buffer_load_dwordx4 v12, s[12:15], s73 offen offset:1024 sc1 lds
  v_exp_f32 v221, v221
  v_exp_f32 v222, v222
  v_exp_f32 v223, v223
  s_waitcnt vmcnt(5)
  v_cmp_eq_u32 vcc, s51, v4
  s_nop 0
  s_lshr_b32 s76, vcc_lo, 16
  s_and_b32 s76, s76, vcc_lo
  s_lshr_b32 s58, s76, 8
  s_and_b32 s76, s76, s58
  s_and_b32 s76, s76, 0xff
  v_exp_f32 v192, v192
  v_exp_f32 v193, v193
  v_smfmac_f32_32x32x32_bf16 v[160:175], v[112:115], v[216:223], v10
  v_exp_f32 v194, v194
  v_exp_f32 v195, v195
  v_exp_f32 v196, v196
  s_waitcnt lgkmcnt(2)
  s_setprio 1
  v_mfma_f32_32x32x16_bf16 v[208:223], v[136:139], v[128:131], v[176:191]
  ds_read_b128 v[136:139], v8 offset:40960
  v_exp_f32 v197, v197
  v_exp_f32 v198, v198
  v_exp_f32 v199, v199
  v_mfma_f32_32x32x16_bf16 v[208:223], v[140:143], v[132:135], v[208:223]
  ds_read_b128 v[140:143], v8 offset:41984
  v_exp_f32 v200, v200
  v_exp_f32 v201, v201
  v_exp_f32 v202, v202
  v_exp_f32 v203, v203
  v_exp_f32 v204, v204
  v_smfmac_f32_32x32x32_bf16 v[160:175], v[144:147], v[192:199], v10
  ds_read_b128 v[144:147], v8 offset:43008
  ds_read_b128 v[112:115], v8 offset:44032
  s_add_u32 m0, s74, 0
  s_nop 0
  buffer_load_dwordx4 v12, s[12:15], s73 offen offset:2048 sc1 lds
  v_exp_f32 v205, v205
  v_exp_f32 v206, v206
  v_exp_f32 v207, v207
  v_exp_f32 v208, v208
  v_exp_f32 v209, v209
  v_smfmac_f32_32x32x32_bf16 v[160:175], v[116:119], v[200:207], v10
  v_exp_f32 v210, v210
  v_exp_f32 v211, v211
  v_exp_f32 v212, v212
  s_waitcnt lgkmcnt(2)
  s_setprio 0
  v_mfma_f32_32x32x16_bf16 v[192:207], v[136:139], v[128:131], v[176:191]
  ds_read_b128 v[136:139], v8 offset:45056
  v_exp_f32 v213, v213
  v_exp_f32 v214, v214
  v_exp_f32 v215, v215
  v_mfma_f32_32x32x16_bf16 v[192:207], v[140:143], v[132:135], v[192:207]
  ds_read_b128 v[140:143], v8 offset:46080
  v_exp_f32 v216, v216
  v_exp_f32 v217, v217
  v_exp_f32 v218, v218
  v_exp_f32 v219, v219
  v_exp_f32 v220, v220
  v_smfmac_f32_32x32x32_bf16 v[160:175], v[148:151], v[208:215], v10
  ds_read_b128 v[148:151], v8 offset:47104
  ds_read_b128 v[116:119], v8 offset:48128
  s_add_u32 m0, s74, 0
  s_nop 0
  buffer_load_dwordx4 v12, s[12:15], s73 offen offset:3072 sc1 lds
  s_add_u32 s73, s73, 16384
  s_and_b32 s73, s73, 0x1ffff
  v_exp_f32 v221, v221
  v_exp_f32 v222, v222
  v_exp_f32 v223, v223
  s_waitcnt vmcnt(4)
  s_lshl3_add_u32 s60, s49, s46
  s_lshl4_add_u32 s60, s60, s45
  s_lshl_b32 s60, s60, 6
  s_add_u32 s60, s60, 131072
  v_mov_b32 v247, s60
  v_mov_b32 v248, s51
  s_mov_b64 exec, 1
  buffer_store_dword v248, v247, s[12:15], 0 offen sc1
  s_mov_b64 exec, -1
  s_cmp_eq_u32 s46, 7
  s_cbranch_scc1 L_w_61
L_w_61_b:
  v_exp_f32 v192, v192
  v_exp_f32 v193, v193
  v_smfmac_f32_32x32x32_bf16 v[160:175], v[120:123], v[216:223], v10
  v_exp_f32 v194, v194
  v_exp_f32 v195, v195
  v_exp_f32 v196, v196
  s_waitcnt lgkmcnt(0)
  s_barrier
  s_setprio 3
  v_mfma_f32_32x32x16_bf16 v[208:223], v[136:139], v[128:131], v[176:191]
  ds_read_b128 v[136:139], v9 offset:0
  s_bitcmp1_b32 s76, 4
  s_cbranch_scc0 L_kp_62
L_kpd_63:
  s_add_u32 m0, s74, 32768
  s_nop 0
  buffer_load_dwordx4 v12, s[12:15], s73 offen offset:0 sc1 lds
  v_exp_f32 v197, v197
  v_exp_f32 v198, v198
  v_exp_f32 v199, v199
  v_mfma_f32_32x32x16_bf16 v[208:223], v[140:143], v[132:135], v[208:223]
  ds_read_b128 v[140:143], v9 offset:1024
  v_exp_f32 v200, v200
  v_exp_f32 v201, v201
  v_exp_f32 v202, v202
  v_exp_f32 v203, v203
  v_exp_f32 v204, v204
  v_smfmac_f32_32x32x32_bf16 v[160:175], v[144:147], v[192:199], v10
  ds_read_b128 v[144:147], v9 offset:2048
  ds_read_b128 v[120:123], v9 offset:3072
  s_add_u32 m0, s74, 32768
  s_nop 0
  buffer_load_dwordx4 v12, s[12:15], s73 offen offset:1024 sc1 lds
  v_exp_f32 v205, v205
  v_exp_f32 v206, v206
  v_exp_f32 v207, v207
  v_exp_f32 v208, v208
  v_exp_f32 v209, v209
  v_smfmac_f32_32x32x32_bf16 v[160:175], v[112:115], v[200:207], v10
  v_exp_f32 v210, v210
  v_exp_f32 v211, v211
  v_exp_f32 v212, v212
  s_waitcnt lgkmcnt(2)
  s_setprio 2
  v_mfma_f32_32x32x16_bf16 v[192:207], v[136:139], v[128:131], v[176:191]
  ds_read_b128 v[136:139], v9 offset:4096
  v_exp_f32 v213, v213
  v_exp_f32 v214, v214
  v_exp_f32 v215, v215
  v_mfma_f32_32x32x16_bf16 v[192:207], v[140:143], v[132:135], v[192:207]
  ds_read_b128 v[140:143], v9 offset:5120
  v_exp_f32 v216, v216
  v_exp_f32 v217, v217
  v_exp_f32 v218, v218
  v_exp_f32 v219, v219
  v_exp_f32 v220, v220
  v_smfmac_f32_32x32x32_bf16 v[160:175], v[148:151], v[208:215], v10
  ds_read_b128 v[148:151], v9 offset:6144
  ds_read_b128 v[112:115], v9 offset:7168
  s_add_u32 m0, s74, 32768
  s_nop 0
  buffer_load_dwordx4 v12, s[12:15], s73 offen offset:2048 sc1 lds
  v_exp_f32 v221, v221
  v_exp_f32 v222, v222
  v_exp_f32 v223, v223
  v_mov_b32 v24, -1
  v_mov_b32 v25, -1
  v_mov_b32 v26, -1
  v_mov_b32 v27, -1
  buffer_store_dwordx4 v[24:27], v246, s[12:15], 0 offen sc1
  v_exp_f32 v192, v192
  v_exp_f32 v193, v193
  v_smfmac_f32_32x32x32_bf16 v[160:175], v[116:119], v[216:223], v10
  v_exp_f32 v194, v194
  v_exp_f32 v195, v195
  v_exp_f32 v196, v196
  s_waitcnt lgkmcnt(2)
  s_setprio 1
  v_mfma_f32_32x32x16_bf16 v[208:223], v[136:139], v[128:131], v[176:191]
  ds_read_b128 v[136:139], v9 offset:8192
  v_exp_f32 v197, v197
  v_exp_f32 v198, v198
  v_exp_f32 v199, v199
  v_mfma_f32_32x32x16_bf16 v[208:223], v[140:143], v[132:135], v[208:223]
  ds_read_b128 v[140:143], v9 offset:9216
  v_exp_f32 v200, v200
  v_exp_f32 v201, v201
  v_exp_f32 v202, v202
  v_exp_f32 v203, v203
  v_exp_f32 v204, v204
  v_smfmac_f32_32x32x32_bf16 v[160:175], v[144:147], v[192:199], v10
  ds_read_b128 v[144:147], v9 offset:10240
  ds_read_b128 v[116:119], v9 offset:11264
  s_add_u32 m0, s74, 32768
  s_nop 0
  buffer_load_dwordx4 v12, s[12:15], s73 offen offset:3072 sc1 lds
  s_add_u32 s73, s73, 16384
  s_and_b32 s73, s73, 0x1ffff
  v_exp_f32 v205, v205
  v_exp_f32 v206, v206
  v_exp_f32 v207, v207
  v_exp_f32 v208, v208
  v_exp_f32 v209, v209
  v_smfmac_f32_32x32x32_bf16 v[160:175], v[120:123], v[200:207], v10
  v_exp_f32 v210, v210
  v_exp_f32 v211, v211
  v_exp_f32 v212, v212
  s_waitcnt lgkmcnt(2)
  s_setprio 0
  v_mfma_f32_32x32x16_bf16 v[192:207], v[136:139], v[128:131], v[176:191]
  ds_read_b128 v[136:139], v9 offset:12288
  v_exp_f32 v213, v213
  v_exp_f32 v214, v214
  v_exp_f32 v215, v215
  v_mfma_f32_32x32x16_bf16 v[192:207], v[140:143], v[132:135], v[192:207]
  ds_read_b128 v[140:143], v9 offset:13312
  v_exp_f32 v216, v216
  v_exp_f32 v217, v217
  v_exp_f32 v218, v218
  v_exp_f32 v219, v219
  v_exp_f32 v220, v220
  v_smfmac_f32_32x32x32_bf16 v[160:175], v[148:151], v[208:215], v10
  ds_read_b128 v[148:151], v9 offset:14336
  ds_read_b128 v[120:123], v9 offset:15360
  v_exp_f32 v221, v221
  v_exp_f32 v222, v222
  v_exp_f32 v223, v223
  s_lshl3_add_u32 s60, s53, s46
  s_lshl_b32 s61, s60, 10
  s_add_u32 s61, s61, 131072
  v_and_b32 v14, 15, v1
  v_lshl_add_u32 v14, v14, 6, s61
  buffer_load_dword v124, v14, s[12:15], 0 offen sc1
  s_lshl_b32 s60, s60, 13
  s_add_u32 s60, s60, 5242880
  v_lshl_add_u32 v7, v1, 4, s60
  v_exp_f32 v192, v192
  v_exp_f32 v193, v193
  v_smfmac_f32_32x32x32_bf16 v[160:175], v[112:115], v[216:223], v10
  v_exp_f32 v194, v194
  v_exp_f32 v195, v195
  v_exp_f32 v196, v196
  s_waitcnt vmcnt(7) lgkmcnt(0)
  s_barrier
  s_setprio 3
  v_mfma_f32_32x32x16_bf16 v[208:223], v[136:139], v[128:131], v[176:191]
  ds_read_b128 v[136:139], v8 offset:0
  s_bitcmp1_b32 s76, 5
  s_cbranch_scc0 L_kp_64
L_kpd_65:
  s_add_u32 m0, s74, 65536
  s_nop 0
  buffer_load_dwordx4 v12, s[12:15], s73 offen offset:0 sc1 lds
  v_exp_f32 v197, v197
  v_exp_f32 v198, v198
  v_exp_f32 v199, v199
  v_mfma_f32_32x32x16_bf16 v[208:223], v[140:143], v[132:135], v[208:223]
  ds_read_b128 v[140:143], v8 offset:1024
  v_exp_f32 v200, v200
  v_exp_f32 v201, v201
  v_exp_f32 v202, v202
  v_exp_f32 v203, v203
  v_exp_f32 v204, v204
  v_smfmac_f32_32x32x32_bf16 v[160:175], v[144:147], v[192:199], v10
  ds_read_b128 v[144:147], v8 offset:2048
  ds_read_b128 v[112:115], v8 offset:3072
  s_add_u32 m0, s74, 65536
  s_nop 0
  buffer_load_dwordx4 v12, s[12:15], s73 offen offset:1024 sc1 lds
  v_exp_f32 v205, v205
  v_exp_f32 v206, v206
  v_exp_f32 v207, v207
  v_exp_f32 v208, v208
  v_exp_f32 v209, v209
  v_smfmac_f32_32x32x32_bf16 v[160:175], v[116:119], v[200:207], v10
  v_exp_f32 v210, v210
  v_exp_f32 v211, v211
  v_exp_f32 v212, v212
  s_waitcnt lgkmcnt(2)
  s_setprio 2
  v_mfma_f32_32x32x16_bf16 v[192:207], v[136:139], v[128:131], v[176:191]
  ds_read_b128 v[136:139], v8 offset:4096
  v_exp_f32 v213, v213
  v_exp_f32 v214, v214
  v_exp_f32 v215, v215
  v_mfma_f32_32x32x16_bf16 v[192:207], v[140:143], v[132:135], v[192:207]
  ds_read_b128 v[140:143], v8 offset:5120
  v_exp_f32 v216, v216
  v_exp_f32 v217, v217
  v_exp_f32 v218, v218
  v_exp_f32 v219, v219
  v_exp_f32 v220, v220
  v_smfmac_f32_32x32x32_bf16 v[160:175], v[148:151], v[208:215], v10
  ds_read_b128 v[148:151], v8 offset:6144
  ds_read_b128 v[116:119], v8 offset:7168
  s_add_u32 m0, s74, 65536
  s_nop 0
  buffer_load_dwordx4 v12, s[12:15], s73 offen offset:2048 sc1 lds
  v_exp_f32 v221, v221
  v_exp_f32 v222, v222
  v_exp_f32 v223, v223
  s_waitcnt vmcnt(3)
  v_cmp_ne_u32 vcc, s51, v124
  s_cbranch_vccnz L_poll_66
L_polled_67:
  v_exp_f32 v192, v192
  v_exp_f32 v193, v193
  v_smfmac_f32_32x32x32_bf16 v[160:175], v[120:123], v[216:223], v10
  v_exp_f32 v194, v194
  v_exp_f32 v195, v195
  v_exp_f32 v196, v196
  s_waitcnt lgkmcnt(2)
  s_setprio 1
  v_mfma_f32_32x32x16_bf16 v[208:223], v[136:139], v[128:131], v[176:191]
  ds_read_b128 v[136:139], v8 offset:8192
  s_add_u32 m0, s74, 65536
  s_nop 0
  buffer_load_dwordx4 v12, s[12:15], s73 offen offset:3072 sc1 lds
  s_add_u32 s73, s73, 16384
  s_and_b32 s73, s73, 0x1ffff
  v_exp_f32 v197, v197
  v_exp_f32 v198, v198
  v_exp_f32 v199, v199
  v_mfma_f32_32x32x16_bf16 v[208:223], v[140:143], v[132:135], v[208:223]
  ds_read_b128 v[140:143], v8 offset:9216
  buffer_load_dwordx4 v[48:51], v7, s[12:15], 0 offen offset:0 sc1
  v_exp_f32 v200, v200
  v_exp_f32 v201, v201
  v_exp_f32 v202, v202
  v_exp_f32 v203, v203
  v_exp_f32 v204, v204
  v_smfmac_f32_32x32x32_bf16 v[160:175], v[144:147], v[192:199], v10
  ds_read_b128 v[144:147], v8 offset:10240
  ds_read_b128 v[120:123], v8 offset:11264
  buffer_load_dwordx4 v[52:55], v7, s[12:15], 0 offen offset:1024 sc1
  v_exp_f32 v205, v205
  v_exp_f32 v206, v206
  v_exp_f32 v207, v207
  v_exp_f32 v208, v208
  v_exp_f32 v209, v209
  v_smfmac_f32_32x32x32_bf16 v[160:175], v[112:115], v[200:207], v10
  v_exp_f32 v210, v210
  v_exp_f32 v211, v211
  v_exp_f32 v212, v212
  s_waitcnt lgkmcnt(2)
  s_setprio 0
  v_mfma_f32_32x32x16_bf16 v[192:207], v[136:139], v[128:131], v[176:191]
  ds_read_b128 v[136:139], v8 offset:12288
  buffer_load_dwordx4 v[56:59], v7, s[12:15], 0 offen offset:2048 sc1
  v_exp_f32 v213, v213
  v_exp_f32 v214, v214
  v_exp_f32 v215, v215
  v_mfma_f32_32x32x16_bf16 v[192:207], v[140:143], v[132:135], v[192:207]
  ds_read_b128 v[140:143], v8 offset:13312
  v_exp_f32 v216, v216
  v_exp_f32 v217, v217
  v_exp_f32 v218, v218
  v_exp_f32 v219, v219
  v_exp_f32 v220, v220
  v_smfmac_f32_32x32x32_bf16 v[160:175], v[148:151], v[208:215], v10
  ds_read_b128 v[148:151], v8 offset:14336
  ds_read_b128 v[112:115], v8 offset:15360
  buffer_load_dwordx4 v[60:63], v7, s[12:15], 0 offen offset:3072 sc1
  v_exp_f32 v221, v221
  v_exp_f32 v222, v222
  v_exp_f32 v223, v223
  v_exp_f32 v192, v192
  v_exp_f32 v193, v193
  v_smfmac_f32_32x32x32_bf16 v[160:175], v[116:119], v[216:223], v10
  v_exp_f32 v194, v194
  v_exp_f32 v195, v195
  v_exp_f32 v196, v196
  s_waitcnt lgkmcnt(0)
  s_barrier
  s_setprio 3
  v_mfma_f32_32x32x16_bf16 v[208:223], v[136:139], v[128:131], v[176:191]
  ds_read_b128 v[136:139], v8 offset:32768
  s_bitcmp1_b32 s76, 6
  s_cbranch_scc0 L_kp_68
L_kpd_69:
  s_add_u32 m0, s74, 0
  s_nop 0
  buffer_load_dwordx4 v12, s[12:15], s73 offen offset:0 sc1 lds
  v_exp_f32 v197, v197
  v_exp_f32 v198, v198
  v_exp_f32 v199, v199
  v_mfma_f32_32x32x16_bf16 v[208:223], v[140:143], v[132:135], v[208:223]
  ds_read_b128 v[140:143], v8 offset:33792
  s_add_u32 m0, s74, 0
  s_nop 0
  buffer_load_dwordx4 v12, s[12:15], s73 offen offset:1024 sc1 lds
  v_exp_f32 v200, v200
  v_exp_f32 v201, v201
  v_exp_f32 v202, v202
  v_exp_f32 v203, v203
  v_exp_f32 v204, v204
  v_smfmac_f32_32x32x32_bf16 v[160:175], v[144:147], v[192:199], v10
  ds_read_b128 v[144:147], v8 offset:34816
  ds_read_b128 v[116:119], v8 offset:35840
  s_add_u32 m0, s74, 0
  s_nop 0
  buffer_load_dwordx4 v12, s[12:15], s73 offen offset:2048 sc1 lds
  v_exp_f32 v205, v205
  v_exp_f32 v206, v206
  v_exp_f32 v207, v207
  v_exp_f32 v208, v208
  v_exp_f32 v209, v209
  v_smfmac_f32_32x32x32_bf16 v[160:175], v[120:123], v[200:207], v10
  v_exp_f32 v210, v210
  v_exp_f32 v211, v211
  v_exp_f32 v212, v212
  s_waitcnt lgkmcnt(2)
  s_setprio 2
  v_mfma_f32_32x32x16_bf16 v[192:207], v[136:139], v[128:131], v[176:191]
  ds_read_b128 v[136:139], v8 offset:36864
  s_add_u32 m0, s74, 0
  s_nop 0
  buffer_load_dwordx4 v12, s[12:15], s73 offen offset:3072 sc1 lds
  s_add_u32 s73, s73, 16384
  s_and_b32 s73, s73, 0x1ffff
  v_exp_f32 v213, v213
  v_exp_f32 v214, v214
  v_exp_f32 v215, v215
  v_mfma_f32_32x32x16_bf16 v[192:207], v[140:143], v[132:135], v[192:207]
  ds_read_b128 v[140:143], v8 offset:37888
  buffer_load_dwordx4 v[64:67], v7, s[12:15], s52 offen offset:0 sc1
  v_exp_f32 v216, v216
  v_exp_f32 v217, v217
  v_exp_f32 v218, v218
  v_exp_f32 v219, v219
  v_exp_f32 v220, v220
  v_smfmac_f32_32x32x32_bf16 v[160:175], v[148:151], v[208:215], v10
  ds_read_b128 v[148:151], v8 offset:38912
  ds_read_b128 v[120:123], v8 offset:39936
  buffer_load_dwordx4 v[68:71], v7, s[12:15], s52 offen offset:1024 sc1
  v_exp_f32 v221, v221
  v_exp_f32 v222, v222
  v_exp_f32 v223, v223
  v_exp_f32 v192, v192
  v_exp_f32 v193, v193
  v_smfmac_f32_32x32x32_bf16 v[160:175], v[112:115], v[216:223], v10
  v_exp_f32 v194, v194
  v_exp_f32 v195, v195
  v_exp_f32 v196, v196
  s_waitcnt lgkmcnt(2)
  s_setprio 1
  v_mfma_f32_32x32x16_bf16 v[208:223], v[136:139], v[128:131], v[176:191]
  ds_read_b128 v[136:139], v8 offset:40960
  buffer_load_dwordx4 v[72:75], v7, s[12:15], s52 offen offset:2048 sc1
  v_exp_f32 v197, v197
  v_exp_f32 v198, v198
  v_exp_f32 v199, v199
  v_mfma_f32_32x32x16_bf16 v[208:223], v[140:143], v[132:135], v[208:223]
  ds_read_b128 v[140:143], v8 offset:41984
  buffer_load_dwordx4 v[76:79], v7, s[12:15], s52 offen offset:3072 sc1
  v_exp_f32 v200, v200
  v_exp_f32 v201, v201
  v_exp_f32 v202, v202
  v_exp_f32 v203, v203
  v_exp_f32 v204, v204
  v_smfmac_f32_32x32x32_bf16 v[160:175], v[144:147], v[192:199], v10
  ds_read_b128 v[144:147], v8 offset:43008
  ds_read_b128 v[112:115], v8 offset:44032
  s_mul_i32 s82, s47, 7168
  s_mul_i32 s81, s47, 50176
  s_add_u32 s82, s82, 126976
  s_add_u32 s81, s81, 200704
  s_mul_i32 s83, s91, 56
  s_lshl3_add_u32 m0, s91, s82
  s_add_u32 s83, s83, s81
  buffer_load_dwordx4 v13, s[8:11], s83 offen lds
  v_exp_f32 v205, v205
  v_exp_f32 v206, v206
  v_exp_f32 v207, v207
  s_waitcnt vmcnt(1)
  v_exp_f32 v208, v208
  v_mfma_f32_16x16x32_bf16 v[20:23], v[16:19], v[48:51], 0
  v_exp_f32 v209, v209
  v_mfma_f32_16x16x32_bf16 v[20:23], v[16:19], v[52:55], v[20:23]
  v_smfmac_f32_32x32x32_bf16 v[160:175], v[116:119], v[200:207], v10
  v_exp_f32 v210, v210
  v_exp_f32 v211, v211
  v_mfma_f32_16x16x32_bf16 v[20:23], v[16:19], v[56:59], v[20:23]
  v_exp_f32 v212, v212
  s_waitcnt lgkmcnt(2)
  s_setprio 0
  v_mfma_f32_32x32x16_bf16 v[192:207], v[136:139], v[128:131], v[176:191]
  ds_read_b128 v[136:139], v8 offset:45056
  s_mul_i32 s83, s92, 56
  s_lshl3_add_u32 m0, s92, s82
  s_add_u32 s83, s83, s81
  buffer_load_dwordx4 v13, s[8:11], s83 offen lds
  v_exp_f32 v213, v213
  v_mfma_f32_16x16x32_bf16 v[20:23], v[16:19], v[60:63], v[20:23]
  v_exp_f32 v214, v214
  v_mfma_f32_16x16x32_bf16 v[20:23], v[16:19], v[64:67], v[20:23]
  v_exp_f32 v215, v215
  v_mfma_f32_32x32x16_bf16 v[192:207], v[140:143], v[132:135], v[192:207]
  ds_read_b128 v[140:143], v8 offset:46080
  v_exp_f32 v216, v216
  v_mfma_f32_16x16x32_bf16 v[20:23], v[16:19], v[68:71], v[20:23]
  v_exp_f32 v217, v217
  v_exp_f32 v218, v218
  v_mfma_f32_16x16x32_bf16 v[20:23], v[16:19], v[72:75], v[20:23]
  v_exp_f32 v219, v219
  v_mfma_f32_16x16x32_bf16 v[20:23], v[16:19], v[76:79], v[20:23]
  v_exp_f32 v220, v220
  v_smfmac_f32_32x32x32_bf16 v[160:175], v[148:151], v[208:215], v10
  ds_read_b128 v[148:151], v8 offset:47104
  ds_read_b128 v[116:119], v8 offset:48128
  s_mul_i32 s83, s93, 56
  s_lshl3_add_u32 m0, s93, s82
  s_add_u32 s83, s83, s81
  buffer_load_dwordx4 v13, s[8:11], s83 offen lds
  v_exp_f32 v221, v221
  v_exp_f32 v222, v222
  v_exp_f32 v223, v223
  v_subrev_u32 v249, 122880, v242
  v_and_b32 v249, 0x3ff, v249
  s_lshr_b32 s60, s46, 1
  s_lshl_b32 s60, s60, 10
  s_add_u32 s60, s60, 155648
  v_lshl_add_u32 v249, v3, 3, v249
  v_add_u32 v249, s60, v249
  v_cvt_pk_bf16_f32 v20, v20, v21
  v_cvt_pk_bf16_f32 v21, v22, v23
  ds_write_b64 v249, v[20:21]
  v_exp_f32 v192, v192
  v_exp_f32 v193, v193
  v_smfmac_f32_32x32x32_bf16 v[160:175], v[120:123], v[216:223], v10
  v_exp_f32 v194, v194
  v_exp_f32 v195, v195
  v_exp_f32 v196, v196
  s_waitcnt lgkmcnt(0)
  s_barrier
  s_setprio 3
  v_mfma_f32_32x32x16_bf16 v[208:223], v[136:139], v[128:131], v[176:191]
  ds_read_b128 v[136:139], v9 offset:0
  s_bitcmp1_b32 s76, 7
  s_cbranch_scc0 L_kp_70
L_kpd_71:
  s_add_u32 m0, s74, 32768
  s_nop 0
  buffer_load_dwordx4 v12, s[12:15], s73 offen offset:0 sc1 lds
  v_exp_f32 v197, v197
  v_exp_f32 v198, v198
  v_exp_f32 v199, v199
  v_mfma_f32_32x32x16_bf16 v[208:223], v[140:143], v[132:135], v[208:223]
  ds_read_b128 v[140:143], v9 offset:1024
  s_add_u32 m0, s74, 32768
  s_nop 0
  buffer_load_dwordx4 v12, s[12:15], s73 offen offset:1024 sc1 lds
  v_exp_f32 v200, v200
  v_exp_f32 v201, v201
  v_exp_f32 v202, v202
  v_exp_f32 v203, v203
  v_exp_f32 v204, v204
  v_smfmac_f32_32x32x32_bf16 v[160:175], v[144:147], v[192:199], v10
  ds_read_b128 v[144:147], v9 offset:2048
  ds_read_b128 v[120:123], v9 offset:3072
  s_add_u32 m0, s74, 32768
  s_nop 0
  buffer_load_dwordx4 v12, s[12:15], s73 offen offset:2048 sc1 lds
  v_exp_f32 v205, v205
  v_exp_f32 v206, v206
  v_exp_f32 v207, v207
  v_exp_f32 v208, v208
  v_exp_f32 v209, v209
  v_smfmac_f32_32x32x32_bf16 v[160:175], v[112:115], v[200:207], v10
  v_exp_f32 v210, v210
  v_exp_f32 v211, v211
  v_exp_f32 v212, v212
  s_waitcnt lgkmcnt(2)
  s_setprio 2
  v_mfma_f32_32x32x16_bf16 v[192:207], v[136:139], v[128:131], v[176:191]
  ds_read_b128 v[136:139], v9 offset:4096
  s_add_u32 m0, s74, 32768
  s_nop 0
  buffer_load_dwordx4 v12, s[12:15], s73 offen offset:3072 sc1 lds
  s_add_u32 s73, s73, 16384
  s_and_b32 s73, s73, 0x1ffff
  v_exp_f32 v213, v213
  v_exp_f32 v214, v214
  v_exp_f32 v215, v215
  v_mfma_f32_32x32x16_bf16 v[192:207], v[140:143], v[132:135], v[192:207]
  ds_read_b128 v[140:143], v9 offset:5120
  v_exp_f32 v216, v216
  v_exp_f32 v217, v217
  v_exp_f32 v218, v218
  v_exp_f32 v219, v219
  v_exp_f32 v220, v220
  v_smfmac_f32_32x32x32_bf16 v[160:175], v[148:151], v[208:215], v10
  ds_read_b128 v[148:151], v9 offset:6144
  ds_read_b128 v[112:115], v9 offset:7168
  s_mul_i32 s83, s94, 56
  s_lshl3_add_u32 m0, s94, s82
  s_add_u32 s83, s83, s81
  buffer_load_dwordx4 v13, s[8:11], s83 offen lds
  v_exp_f32 v221, v221
  v_exp_f32 v222, v222
  v_exp_f32 v223, v223
  v_exp_f32 v192, v192
  v_exp_f32 v193, v193
  v_smfmac_f32_32x32x32_bf16 v[160:175], v[116:119], v[216:223], v10
  v_exp_f32 v194, v194
  v_exp_f32 v195, v195
  v_exp_f32 v196, v196
  s_waitcnt lgkmcnt(2)
  s_setprio 1
  v_mfma_f32_32x32x16_bf16 v[208:223], v[136:139], v[128:131], v[176:191]
  ds_read_b128 v[136:139], v9 offset:8192
  s_mul_i32 s83, s95, 56
  s_lshl3_add_u32 m0, s95, s82
  s_add_u32 s83, s83, s81
  buffer_load_dwordx4 v13, s[8:11], s83 offen lds
  v_exp_f32 v197, v197
  v_exp_f32 v198, v198
  v_exp_f32 v199, v199
  v_mfma_f32_32x32x16_bf16 v[208:223], v[140:143], v[132:135], v[208:223]
  ds_read_b128 v[140:143], v9 offset:9216
  v_exp_f32 v200, v200
  v_exp_f32 v201, v201
  v_exp_f32 v202, v202
  v_exp_f32 v203, v203
  v_exp_f32 v204, v204
  v_smfmac_f32_32x32x32_bf16 v[160:175], v[144:147], v[192:199], v10
  ds_read_b128 v[144:147], v9 offset:10240
  ds_read_b128 v[116:119], v9 offset:11264
  s_mul_i32 s83, s96, 56
  s_lshl3_add_u32 m0, s96, s82
  s_add_u32 s83, s83, s81
  buffer_load_dwordx4 v13, s[8:11], s83 offen lds
  v_exp_f32 v205, v205
  v_exp_f32 v206, v206
  v_exp_f32 v207, v207
  v_exp_f32 v208, v208
  v_exp_f32 v209, v209
  v_smfmac_f32_32x32x32_bf16 v[160:175], v[120:123], v[200:207], v10
  v_exp_f32 v210, v210
  v_exp_f32 v211, v211
  v_exp_f32 v212, v212
  s_waitcnt lgkmcnt(2)
  s_setprio 0
  v_mfma_f32_32x32x16_bf16 v[192:207], v[136:139], v[128:131], v[176:191]
  ds_read_b128 v[136:139], v9 offset:12288
  v_exp_f32 v213, v213
  v_exp_f32 v214, v214
  v_exp_f32 v215, v215
  v_mfma_f32_32x32x16_bf16 v[192:207], v[140:143], v[132:135], v[192:207]
  ds_read_b128 v[140:143], v9 offset:13312
  v_exp_f32 v216, v216
  v_exp_f32 v217, v217
  v_exp_f32 v218, v218
  v_exp_f32 v219, v219
  v_exp_f32 v220, v220
  v_smfmac_f32_32x32x32_bf16 v[160:175], v[148:151], v[208:215], v10
  ds_read_b128 v[148:151], v9 offset:14336
  ds_read_b128 v[120:123], v9 offset:15360
  s_mul_i32 s83, s97, 56
  s_lshl3_add_u32 m0, s97, s82
  s_add_u32 s83, s83, s81
  buffer_load_dwordx4 v13, s[8:11], s83 offen lds
  v_exp_f32 v221, v221
  v_exp_f32 v222, v222
  v_exp_f32 v223, v223
  v_exp_f32 v192, v192
  v_exp_f32 v193, v193
  v_smfmac_f32_32x32x32_bf16 v[160:175], v[112:115], v[216:223], v10
  v_exp_f32 v194, v194
  v_exp_f32 v195, v195
  v_exp_f32 v196, v196
  s_waitcnt lgkmcnt(0)
  s_barrier
  s_setprio 3
  v_mfma_f32_32x32x16_bf16 v[208:223], v[136:139], v[128:131], v[176:191]
  ds_read_b128 v[136:139], v8 offset:0
  s_mul_i32 s82, s47, 3072
  s_mul_i32 s81, s47, 21504
  s_add_u32 m0, s82, 81920
  s_add_u32 s83, s81, 114688
  buffer_load_dwordx4 v13, s[4:7], s83 offen lds
  v_exp_f32 v197, v197
  v_exp_f32 v198, v198
  v_exp_f32 v199, v199
  v_mfma_f32_32x32x16_bf16 v[208:223], v[140:143], v[132:135], v[208:223]
  ds_read_b128 v[140:143], v8 offset:1024
  v_exp_f32 v200, v200
  v_exp_f32 v201, v201
  v_exp_f32 v202, v202
  v_exp_f32 v203, v203
  v_exp_f32_e64 v204, v204
  v_smfmac_f32_32x32x32_bf16 v[160:175], v[144:147], v[192:199], v10
  ds_read_b128 v[144:147], v8 offset:2048
  ds_read_b128 v[112:115], v8 offset:3072
  s_add_u32 m0, s82, 82944
  s_add_u32 s83, s81, 121856
  buffer_load_dwordx4 v13, s[4:7], s83 offen lds
  v_exp_f32 v205, v205
  v_exp_f32 v206, v206
  v_exp_f32 v207, v207
  v_exp_f32 v208, v208
  v_exp_f32 v209, v209
  v_smfmac_f32_32x32x32_bf16 v[160:175], v[116:119], v[200:207], v10
  v_exp_f32 v210, v210
  v_exp_f32 v211, v211
  v_exp_f32 v212, v212
  s_waitcnt lgkmcnt(2)
  s_setprio 2
  v_mfma_f32_32x32x16_bf16 v[192:207], v[136:139], v[128:131], v[176:191]
  ds_read_b128 v[136:139], v8 offset:4096
  v_exp_f32 v213, v213
  v_exp_f32 v214, v214
  v_exp_f32 v215, v215
  v_mfma_f32_32x32x16_bf16 v[192:207], v[140:143], v[132:135], v[192:207]
  ds_read_b128 v[140:143], v8 offset:5120
  v_exp_f32 v216, v216
  v_exp_f32 v217, v217
  v_exp_f32 v218, v218
  v_exp_f32 v219, v219
  v_exp_f32 v220, v220
  v_smfmac_f32_32x32x32_bf16 v[160:175], v[148:151], v[208:215], v10
  ds_read_b128 v[148:151], v8 offset:6144
  ds_read_b128 v[116:119], v8 offset:7168
  s_add_u32 m0, s82, 83968
  s_add_u32 s83, s81, 129024
  buffer_load_dwordx4 v13, s[4:7], s83 offen lds
  v_exp_f32 v221, v221
  v_exp_f32 v222, v222
  v_exp_f32 v223, v223
  v_exp_f32 v192, v192
  v_exp_f32 v193, v193
  v_smfmac_f32_32x32x32_bf16 v[160:175], v[120:123], v[216:223], v10
  v_exp_f32 v194, v194
  v_exp_f32 v195, v195
  v_exp_f32 v196, v196
  s_waitcnt lgkmcnt(2)
  s_setprio 1
  v_mfma_f32_32x32x16_bf16 v[208:223], v[136:139], v[128:131], v[176:191]
  ds_read_b128 v[136:139], v8 offset:8192
  v_exp_f32 v197, v197
  v_exp_f32 v198, v198
  v_exp_f32 v199, v199
  v_mfma_f32_32x32x16_bf16 v[208:223], v[140:143], v[132:135], v[208:223]
  ds_read_b128 v[140:143], v8 offset:9216
  v_exp_f32 v200, v200
  v_exp_f32 v201, v201
  v_exp_f32 v202, v202
  v_exp_f32 v203, v203
  v_exp_f32 v204, v204
  v_smfmac_f32_32x32x32_bf16 v[160:175], v[144:147], v[192:199], v10
  ds_read_b128 v[144:147], v8 offset:10240
  ds_read_b128 v[120:123], v8 offset:11264
  v_exp_f32 v205, v205
  v_exp_f32 v206, v206
  v_exp_f32 v207, v207
  v_exp_f32 v208, v208
  v_exp_f32 v209, v209
  v_smfmac_f32_32x32x32_bf16 v[160:175], v[112:115], v[200:207], v10
  v_exp_f32 v210, v210
  v_exp_f32 v211, v211
  v_exp_f32 v212, v212
  s_waitcnt lgkmcnt(2)
  s_setprio 0
  v_mfma_f32_32x32x16_bf16 v[192:207], v[136:139], v[128:131], v[176:191]
  ds_read_b128 v[136:139], v8 offset:12288
  v_exp_f32 v213, v213
  v_exp_f32 v214, v214
  v_exp_f32 v215, v215
  v_mfma_f32_32x32x16_bf16 v[192:207], v[140:143], v[132:135], v[192:207]
  ds_read_b128 v[140:143], v8 offset:13312
  v_exp_f32 v216, v216
  v_exp_f32 v217, v217
  v_exp_f32 v218, v218
  v_exp_f32 v219, v219
  v_exp_f32 v220, v220
  v_smfmac_f32_32x32x32_bf16 v[160:175], v[148:151], v[208:215], v10
  ds_read_b128 v[148:151], v8 offset:14336
  ds_read_b128 v[112:115], v8 offset:15360
  v_exp_f32 v221, v221
  v_exp_f32 v222, v222
  v_exp_f32 v223, v223
  s_lshl_b32 s60, s55, 10
  s_add_u32 s60, s60, 393216
  v_and_b32 v245, 15, v1
  v_lshl_add_u32 v245, v245, 6, s60
  buffer_load_dword v244, v245, s[12:15], 0 offen sc1
  v_exp_f32 v192, v192
  v_exp_f32 v193, v193
  v_smfmac_f32_32x32x32_bf16 v[160:175], v[116:119], v[216:223], v10
  v_exp_f32 v194, v194
  v_exp_f32 v195, v195
  v_exp_f32 v196, v196
  s_waitcnt vmcnt(8) lgkmcnt(0)
  s_barrier
  s_setprio 3
  v_mfma_f32_32x32x16_bf16 v[208:223], v[136:139], v[128:131], v[176:191]
  ds_read_b128 v[136:139], v8 offset:32768
  s_mul_i32 s82, s47, 3072
  s_mul_i32 s81, s47, 21504
  s_add_u32 m0, s82, 16384
  s_add_u32 s83, s81, 315392
  buffer_load_dwordx4 v13, s[4:7], s83 offen lds
  v_exp_f32 v197, v197
  v_exp_f32 v198, v198
  v_exp_f32 v199, v199
  v_mfma_f32_32x32x16_bf16 v[208:223], v[140:143], v[132:135], v[208:223]
  ds_read_b128 v[140:143], v8 offset:33792
  v_exp_f32 v200, v200
  v_exp_f32 v201, v201
  v_exp_f32 v202, v202
  v_exp_f32 v203, v203
  v_exp_f32_e64 v204, v204
  v_smfmac_f32_32x32x32_bf16 v[160:175], v[144:147], v[192:199], v10
  ds_read_b128 v[144:147], v8 offset:34816
  ds_read_b128 v[116:119], v8 offset:35840
  s_add_u32 m0, s82, 17408
  s_add_u32 s83, s81, 322560
  buffer_load_dwordx4 v13, s[4:7], s83 offen lds
  v_exp_f32 v205, v205
  v_exp_f32 v206, v206
  v_exp_f32 v207, v207
  v_exp_f32 v208, v208
  v_exp_f32 v209, v209
  v_smfmac_f32_32x32x32_bf16 v[160:175], v[120:123], v[200:207], v10
  v_exp_f32 v210, v210
  v_exp_f32 v211, v211
  v_exp_f32 v212, v212
  s_waitcnt lgkmcnt(2)
  s_setprio 2
  v_mfma_f32_32x32x16_bf16 v[192:207], v[136:139], v[128:131], v[176:191]
  ds_read_b128 v[136:139], v8 offset:36864
  v_exp_f32 v213, v213
  v_exp_f32 v214, v214
  v_exp_f32 v215, v215
  v_mfma_f32_32x32x16_bf16 v[192:207], v[140:143], v[132:135], v[192:207]
  ds_read_b128 v[140:143], v8 offset:37888
  v_exp_f32 v216, v216
  v_exp_f32 v217, v217
  v_exp_f32 v218, v218
  v_exp_f32 v219, v219
  v_exp_f32 v220, v220
  v_smfmac_f32_32x32x32_bf16 v[160:175], v[148:151], v[208:215], v10
  ds_read_b128 v[148:151], v8 offset:38912
  ds_read_b128 v[120:123], v8 offset:39936
  s_add_u32 m0, s82, 18432
  s_add_u32 s83, s81, 329728
  buffer_load_dwordx4 v13, s[4:7], s83 offen lds
  v_exp_f32 v221, v221
  v_exp_f32 v222, v222
  v_exp_f32 v223, v223
  s_waitcnt vmcnt(3)
  v_cmp_ne_u32 vcc, s51, v244
  s_cbranch_vccnz L_poll_72
L_polled_73:
  s_lshl_b32 s60, s55, 16
  s_lshl_b32 s61, s54, 13
  s_add_u32 s60, s60, s61
  s_add_u32 s60, s60, 8388608
  s_and_b32 s61, s44, 7
  s_cmp_eq_u32 s61, 7
  s_cselect_b32 s60, 1073741824, s60
  v_lshl_add_u32 v7, v1, 4, s60
  v_exp_f32 v192, v192
  v_exp_f32 v193, v193
  v_smfmac_f32_32x32x32_bf16 v[160:175], v[112:115], v[216:223], v10
  v_exp_f32 v194, v194
  v_exp_f32 v195, v195
  v_exp_f32 v196, v196
  s_waitcnt lgkmcnt(2)
  s_setprio 1
  v_mfma_f32_32x32x16_bf16 v[208:223], v[136:139], v[128:131], v[176:191]
  ds_read_b128 v[136:139], v8 offset:40960
  buffer_load_dwordx4 v[80:83], v7, s[12:15], 0 offen offset:0 sc1
  v_exp_f32 v197, v197
  v_exp_f32 v198, v198
  v_exp_f32 v199, v199
  v_mfma_f32_32x32x16_bf16 v[208:223], v[140:143], v[132:135], v[208:223]
  ds_read_b128 v[140:143], v8 offset:41984
  buffer_load_dwordx4 v[84:87], v7, s[12:15], 0 offen offset:1024 sc1
  v_exp_f32 v200, v200
  v_exp_f32 v201, v201
  v_exp_f32 v202, v202
  v_exp_f32 v203, v203
  v_exp_f32 v204, v204
  v_smfmac_f32_32x32x32_bf16 v[160:175], v[144:147], v[192:199], v10
  ds_read_b128 v[144:147], v8 offset:43008
  ds_read_b128 v[112:115], v8 offset:44032
  buffer_load_dwordx4 v[88:91], v7, s[12:15], 0 offen offset:2048 sc1
  v_exp_f32 v205, v205
  v_exp_f32 v206, v206
  v_exp_f32 v207, v207
  v_exp_f32 v208, v208
  v_exp_f32 v209, v209
  v_smfmac_f32_32x32x32_bf16 v[160:175], v[116:119], v[200:207], v10
  v_exp_f32 v210, v210
  v_exp_f32 v211, v211
  v_exp_f32 v212, v212
  s_waitcnt lgkmcnt(2)
  s_setprio 0
  v_mfma_f32_32x32x16_bf16 v[192:207], v[136:139], v[128:131], v[176:191]
  ds_read_b128 v[136:139], v8 offset:45056
  buffer_load_dwordx4 v[92:95], v7, s[12:15], 0 offen offset:3072 sc1
  v_exp_f32 v213, v213
  v_exp_f32 v214, v214
  v_exp_f32 v215, v215
  v_mfma_f32_32x32x16_bf16 v[192:207], v[140:143], v[132:135], v[192:207]
  ds_read_b128 v[140:143], v8 offset:46080
  v_exp_f32 v216, v216
  v_exp_f32 v217, v217
  v_exp_f32 v218, v218
  v_exp_f32 v219, v219
  v_exp_f32 v220, v220
  v_smfmac_f32_32x32x32_bf16 v[160:175], v[148:151], v[208:215], v10
  ds_read_b128 v[148:151], v8 offset:47104
  ds_read_b128 v[116:119], v8 offset:48128
  buffer_load_dwordx4 v[96:99], v7, s[12:15], s52 offen offset:0 sc1
  v_exp_f32 v221, v221
  v_exp_f32 v222, v222
  v_exp_f32 v223, v223
  v_exp_f32 v192, v192
  v_exp_f32 v193, v193
  v_smfmac_f32_32x32x32_bf16 v[160:175], v[120:123], v[216:223], v10
  v_exp_f32 v194, v194
  v_exp_f32 v195, v195
  v_exp_f32 v196, v196
  s_waitcnt lgkmcnt(0)
  s_barrier
  s_setprio 3
  v_mfma_f32_32x32x16_bf16 v[208:223], v[136:139], v[128:131], v[176:191]
  buffer_load_dwordx4 v[100:103], v7, s[12:15], s52 offen offset:1024 sc1
  v_exp_f32 v197, v197
  v_exp_f32 v198, v198
  v_exp_f32 v199, v199
  v_mfma_f32_32x32x16_bf16 v[208:223], v[140:143], v[132:135], v[208:223]
  v_exp_f32 v200, v200
  v_exp_f32 v201, v201
  v_exp_f32 v202, v202
  v_exp_f32 v203, v203
  v_exp_f32 v204, v204
  v_smfmac_f32_32x32x32_bf16 v[160:175], v[144:147], v[192:199], v10
  buffer_load_dwordx4 v[104:107], v7, s[12:15], s52 offen offset:2048 sc1
  v_exp_f32 v205, v205
  v_exp_f32 v206, v206
  v_exp_f32 v207, v207
  s_nop 1
  v_exp_f32 v208, v208
  v_exp_f32 v209, v209
  v_smfmac_f32_32x32x32_bf16 v[160:175], v[112:115], v[200:207], v10
  v_exp_f32 v210, v210
  v_exp_f32 v211, v211
  v_exp_f32 v212, v212
  s_setprio 2
  v_exp_f32 v213, v213
  v_exp_f32 v214, v214
  v_exp_f32 v215, v215
  v_exp_f32 v216, v216
  v_exp_f32 v217, v217
  v_exp_f32 v218, v218
  v_exp_f32 v219, v219
  v_exp_f32 v220, v220
  v_smfmac_f32_32x32x32_bf16 v[160:175], v[148:151], v[208:215], v10
  buffer_load_dwordx4 v[108:111], v7, s[12:15], s52 offen offset:3072 sc1
  v_exp_f32 v221, v221
  v_exp_f32 v222, v222
  v_exp_f32 v223, v223
  s_nop 1
  v_smfmac_f32_32x32x32_bf16 v[160:175], v[116:119], v[216:223], v10
  s_setprio 0
  s_lshl_b32 s60, s46, 12
  s_add_u32 s60, s60, 32768
  v_lshl_add_u32 v124, v1, 4, s60
  v_xor_b32 v4, 16384, v124
  v_lshl_add_u32 v5, v1, 3, s60
  v_sub_f32 v8, 1.0, v15
  s_mov_b32 s61, 0x5d800000
  v_mov_b32 v153, v11
  s_nop 2
  v_mov_b32 v152, v172
  v_mov_b32 v247, v172
  ds_write_b128 v124, v[160:163]
  ds_write_b128 v124, v[164:167] offset:1024
  v_permlane32_swap_b32 v247, v152
  v_mul_f32 v248, 0, v160
  v_mul_f32 v249, 0, v161
  ds_write_b64 v5, v[152:153] offset:2048
  v_fma_f32 v248, v162, 0, v248
  v_fma_f32 v249, v163, 0, v249
  v_fma_f32 v248, v164, 0, v248
  v_fma_f32 v249, v165, 0, v249
  v_fma_f32 v248, v166, 0, v248
  v_fma_f32 v249, v167, 0, v249
  v_fma_f32 v248, v168, 0, v248
  v_fma_f32 v249, v169, 0, v249
  v_fma_f32 v248, v170, 0, v248
  v_fma_f32 v249, v171, 0, v249
  v_fma_f32 v248, v172, 0, v248
  v_fma_f32 v249, v173, 0, v249
  v_fma_f32 v248, v174, 0, v248
  v_fma_f32 v249, v175, 0, v249
  v_add_f32 v248, v248, v249
  v_add_f32 v248, v248, v152
  v_cmp_nge_f32 vcc, s61, v248
  s_cbranch_vccnz L_fb_74
L_fbback_75:
  s_mul_i32 s60, s54, 14336
  s_add_u32 s60, s60, 98304
  v_and_b32_e64 v247, 1, v1
  v_bfe_u32 v248, v1, 1, 1
  v_lshl_or_b32 v247, v247, 1, v248
  v_bfe_u32 v248, v1, 4, 1
  v_lshl_or_b32 v247, v248, 2, v247
  v_bfe_u32 v248, v1, 3, 1
  v_lshl_or_b32 v247, v248, 3, v247
  v_bfe_u32 v248, v1, 2, 2
  v_lshlrev_b32 v247, 3, v247
  v_lshl_add_u32 v247, v248, 7, v247
  v_add_u32 v242, s60, v247
  v_xor_b32 v243, 64, v242
  v_lshl_add_u32 v240, v3, 9, v242
  v_xor_b32 v241, 64, v240
  s_and_b32 s61, s54, 1
  s_mul_i32 s61, s61, 14336
  s_cmp_lt_u32 s54, 2
  s_cselect_b32 s62, 65536, 0
  s_add_u32 s61, s61, s62
  s_sub_u32 s61, s61, s60
  v_add_u32 v116, s61, v240
  v_add_u32 v117, s61, v241
  v_add_u32 v118, s61, v242
  v_add_u32 v119, s61, v243
  s_waitcnt vmcnt(8) lgkmcnt(0)
  s_barrier
  v_xor_b32 v5, 16384, v5
  ds_read_b64 v[248:249], v5 offset:2048
  ds_read_b128 v[192:195], v4
  ds_read_b128 v[196:199], v4 offset:1024
  ds_read_b64_tr_b16 v[16:17], v240 offset:0
  ds_read_b64_tr_b16 v[18:19], v240 offset:1024
  ds_read_b64_tr_b16 v[20:21], v241 offset:0
  ds_read_b64_tr_b16 v[22:23], v241 offset:1024
  ds_read_b64_tr_b16 v[24:25], v240 offset:2048
  ds_read_b64_tr_b16 v[26:27], v242 offset:3072
  ds_read_b64_tr_b16 v[28:29], v241 offset:2048
  ds_read_b64_tr_b16 v[30:31], v243 offset:3072
  ds_read_b64_tr_b16 v[32:33], v240 offset:3584
  ds_read_b64_tr_b16 v[34:35], v240 offset:4608
  s_waitcnt lgkmcnt(12)
  v_max_f32 v247, v11, v249
  v_sub_f32 v250, v11, v247
  v_sub_f32 v252, v249, v247
  v_exp_f32 v250, v250
  v_exp_f32 v252, v252
  v_mul_f32 v152, v152, v250
  v_fmac_f32 v152, v248, v252
  v_rcp_f32 v152, v152
  v_mul_f32 v250, v250, v8
  v_mul_f32 v252, v252, v8
  v_mul_f32 v250, v250, v152
  v_mul_f32 v252, v252, v152
  v_mul_f32 v168, v168, v250
  v_mul_f32 v169, v169, v250
  v_mul_f32 v170, v170, v250
  v_mul_f32 v171, v171, v250
  v_mul_f32 v172, v172, v250
  v_mul_f32 v173, v173, v250
  v_mul_f32 v174, v174, v250
  v_mul_f32 v175, v175, v250
  s_waitcnt lgkmcnt(10)
  ds_read_b64_tr_b16 v[36:37], v241 offset:3584
  ds_read_b64_tr_b16 v[38:39], v241 offset:4608
  ds_read_b64_tr_b16 v[40:41], v240 offset:5632
  ds_read_b64_tr_b16 v[42:43], v242 offset:6656
  s_waitcnt lgkmcnt(8)
  s_nop 0
  ds_read_b64_tr_b16 v[44:45], v241 offset:5632
  ds_read_b64_tr_b16 v[46:47], v243 offset:6656
  v_fma_f32 v168, v192, v252, v168
  v_fma_f32 v169, v193, v252, v169
  v_fma_f32 v170, v194, v252, v170
  v_fma_f32 v171, v195, v252, v171
  v_fma_f32 v172, v196, v252, v172
  v_fma_f32 v173, v197, v252, v173
  v_fma_f32 v174, v198, v252, v174
  v_fma_f32 v175, v199, v252, v175
  v_cvt_pk_bf16_f32 v112, v168, v169
  v_cvt_pk_bf16_f32 v113, v170, v171
  v_cvt_pk_bf16_f32 v114, v172, v173
  v_cvt_pk_bf16_f32 v115, v174, v175
  s_mov_b64 exec, s[78:79]
  v_mov_b32 v114, 0
  v_mov_b32 v115, 0
  s_mov_b64 exec, -1
  buffer_store_dwordx4 v[112:115], v246, s[12:15], 0 offen sc1
  s_and_b32 s61, s44, 7
  s_cmp_eq_u32 s61, 7
  s_cbranch_scc1 L_idle_77
  v_add_u32 v9, 32768, v7
  s_waitcnt vmcnt(1)
  v_mfma_f32_32x32x16_bf16 v[128:143], v[16:19], v[80:83], 0
  ds_read_b64_tr_b16 v[48:49], v240 offset:7168
  ds_read_b64_tr_b16 v[50:51], v240 offset:8192
  v_mfma_f32_32x32x16_bf16 v[144:159], v[20:23], v[80:83], 0
  ds_read_b64_tr_b16 v[52:53], v241 offset:7168
  ds_read_b64_tr_b16 v[54:55], v241 offset:8192
  v_mfma_f32_32x32x16_bf16 v[128:143], v[24:27], v[84:87], v[128:143]
  s_waitcnt lgkmcnt(8)
  s_nop 0
  ds_read_b64_tr_b16 v[56:57], v240 offset:9216
  ds_read_b64_tr_b16 v[58:59], v242 offset:10240
  v_mfma_f32_32x32x16_bf16 v[144:159], v[28:31], v[84:87], v[144:159]
  ds_read_b64_tr_b16 v[60:61], v241 offset:9216
  ds_read_b64_tr_b16 v[62:63], v243 offset:10240
  v_mfma_f32_32x32x16_bf16 v[128:143], v[32:35], v[88:91], v[128:143]
  ds_read_b64_tr_b16 v[64:65], v240 offset:10752
  ds_read_b64_tr_b16 v[66:67], v240 offset:11776
  v_mfma_f32_32x32x16_bf16 v[144:159], v[36:39], v[88:91], v[144:159]
  s_waitcnt lgkmcnt(8)
  s_nop 0
  ds_read_b64_tr_b16 v[68:69], v241 offset:10752
  ds_read_b64_tr_b16 v[70:71], v241 offset:11776
  v_mfma_f32_32x32x16_bf16 v[128:143], v[40:43], v[92:95], v[128:143]
  ds_read_b64_tr_b16 v[72:73], v240 offset:12800
  ds_read_b64_tr_b16 v[74:75], v242 offset:13824
  v_mfma_f32_32x32x16_bf16 v[144:159], v[44:47], v[92:95], v[144:159]
  ds_read_b64_tr_b16 v[76:77], v241 offset:12800
  ds_read_b64_tr_b16 v[78:79], v243 offset:13824
  v_mfma_f32_32x32x16_bf16 v[128:143], v[48:51], v[96:99], v[128:143]
  s_waitcnt lgkmcnt(8)
  s_nop 0
  ds_read_b64_tr_b16 v[176:177], v116 offset:0
  ds_read_b64_tr_b16 v[178:179], v116 offset:1024
  ds_read_b64_tr_b16 v[180:181], v117 offset:0
  ds_read_b64_tr_b16 v[182:183], v117 offset:1024
  v_mfma_f32_32x32x16_bf16 v[144:159], v[52:55], v[96:99], v[144:159]
  ds_read_b64_tr_b16 v[184:185], v116 offset:2048
  ds_read_b64_tr_b16 v[186:187], v118 offset:3072
  s_waitcnt lgkmcnt(8)
  s_nop 0
  ds_read_b64_tr_b16 v[188:189], v117 offset:2048
  ds_read_b64_tr_b16 v[190:191], v119 offset:3072
  v_mfma_f32_32x32x16_bf16 v[128:143], v[56:59], v[100:103], v[128:143]
  ds_read_b64_tr_b16 v[192:193], v116 offset:3584
  ds_read_b64_tr_b16 v[194:195], v116 offset:4608
  ds_read_b64_tr_b16 v[196:197], v117 offset:3584
  ds_read_b64_tr_b16 v[198:199], v117 offset:4608
  v_mfma_f32_32x32x16_bf16 v[144:159], v[60:63], v[100:103], v[144:159]
  s_waitcnt lgkmcnt(8)
  s_nop 0
  ds_read_b64_tr_b16 v[200:201], v116 offset:5632
  ds_read_b64_tr_b16 v[202:203], v118 offset:6656
  ds_read_b64_tr_b16 v[204:205], v117 offset:5632
  ds_read_b64_tr_b16 v[206:207], v119 offset:6656
  v_mfma_f32_32x32x16_bf16 v[128:143], v[64:67], v[104:107], v[128:143]
  ds_read_b64_tr_b16 v[208:209], v116 offset:7168
  ds_read_b64_tr_b16 v[210:211], v116 offset:8192
  s_waitcnt lgkmcnt(8)
  s_nop 0
  ds_read_b64_tr_b16 v[212:213], v117 offset:7168
  ds_read_b64_tr_b16 v[214:215], v117 offset:8192
  v_mfma_f32_32x32x16_bf16 v[144:159], v[68:71], v[104:107], v[144:159]
  ds_read_b64_tr_b16 v[216:217], v116 offset:9216
  ds_read_b64_tr_b16 v[218:219], v118 offset:10240
  ds_read_b64_tr_b16 v[220:221], v117 offset:9216
  ds_read_b64_tr_b16 v[222:223], v119 offset:10240
  v_mfma_f32_32x32x16_bf16 v[128:143], v[72:75], v[108:111], v[128:143]
  s_waitcnt lgkmcnt(8)
  s_nop 0
  ds_read_b64_tr_b16 v[224:225], v116 offset:10752
  ds_read_b64_tr_b16 v[226:227], v116 offset:11776
  ds_read_b64_tr_b16 v[228:229], v117 offset:10752
  ds_read_b64_tr_b16 v[230:231], v117 offset:11776
  v_mfma_f32_32x32x16_bf16 v[144:159], v[76:79], v[108:111], v[144:159]
  ds_read_b64_tr_b16 v[232:233], v116 offset:12800
  ds_read_b64_tr_b16 v[234:235], v118 offset:13824
  s_waitcnt lgkmcnt(8)
  ds_read_b64_tr_b16 v[236:237], v117 offset:12800
  ds_read_b64_tr_b16 v[238:239], v119 offset:13824
  s_waitcnt vmcnt(0)
  buffer_load_dwordx4 v[80:83], v9, s[12:15], 0 offen offset:0 sc1
  buffer_load_dwordx4 v[84:87], v9, s[12:15], 0 offen offset:1024 sc1
  buffer_load_dwordx4 v[88:91], v9, s[12:15], 0 offen offset:2048 sc1
  buffer_load_dwordx4 v[92:95], v9, s[12:15], 0 offen offset:3072 sc1
  buffer_load_dwordx4 v[96:99], v9, s[12:15], s52 offen offset:0 sc1
  buffer_load_dwordx4 v[100:103], v9, s[12:15], s52 offen offset:1024 sc1
  buffer_load_dwordx4 v[104:107], v9, s[12:15], s52 offen offset:2048 sc1
  buffer_load_dwordx4 v[108:111], v9, s[12:15], s52 offen offset:3072 sc1
  s_mov_b32 s16, s38
  s_mov_b32 s17, s39
  s_mov_b32 s18, 1835008
  s_mov_b32 s19, 0x20000
  s_lshl_b32 s60, s55, 5
  v_add_u32 v247, s60, v2
  v_mul_u32_u24 v247, 896, v247
  v_lshl_add_u32 v247, v3, 4, v247
  s_and_b32 s60, s44, 7
  s_lshl_b32 s60, s60, 7
  s_lshl_b32 s61, s54, 5
  s_add_u32 s60, s60, s61
  v_add_u32 v14, s60, v247
  s_and_b32 s60, s46, 1
  s_lshl_b32 s60, s60, 15
  s_lshl_b32 s61, s54, 11
  s_add_u32 s61, s61, s60
  v_lshl_add_u32 v12, v1, 4, s61
  s_lshl_b32 s61, s54, 13
  s_add_u32 s61, s61, s60
  v_lshl_add_u32 v126, v1, 4, s61
  s_mov_b32 s75, 262144
  s_waitcnt lgkmcnt(0)
  s_barrier
  s_waitcnt vmcnt(7)
  v_max3_u32 v247, v80, v81, v82
  v_max_u32 v247, v247, v83
  v_cmp_eq_u32 vcc, -1, v247
  s_cbranch_vccnz L_ob_78
L_obd_79:
  v_mfma_f32_32x32x16_bf16 v[128:143], v[176:179], v[80:83], v[128:143]
  v_mfma_f32_32x32x16_bf16 v[144:159], v[180:183], v[80:83], v[144:159]
  s_waitcnt vmcnt(6)
  v_max3_u32 v247, v84, v85, v86
  v_max_u32 v247, v247, v87
  v_cmp_eq_u32 vcc, -1, v247
  s_cbranch_vccnz L_ob_80
L_obd_81:
  v_mfma_f32_32x32x16_bf16 v[128:143], v[184:187], v[84:87], v[128:143]
  v_mfma_f32_32x32x16_bf16 v[144:159], v[188:191], v[84:87], v[144:159]
  s_waitcnt vmcnt(5)
  v_max3_u32 v247, v88, v89, v90
  v_max_u32 v247, v247, v91
  v_cmp_eq_u32 vcc, -1, v247
  s_cbranch_vccnz L_ob_82
L_obd_83:
  v_mfma_f32_32x32x16_bf16 v[128:143], v[192:195], v[88:91], v[128:143]
  v_mfma_f32_32x32x16_bf16 v[144:159], v[196:199], v[88:91], v[144:159]
  s_waitcnt vmcnt(4)
  v_max3_u32 v247, v92, v93, v94
  v_max_u32 v247, v247, v95
  v_cmp_eq_u32 vcc, -1, v247
  s_cbranch_vccnz L_ob_84
L_obd_85:
  v_mfma_f32_32x32x16_bf16 v[128:143], v[200:203], v[92:95], v[128:143]
  v_mfma_f32_32x32x16_bf16 v[144:159], v[204:207], v[92:95], v[144:159]
  s_waitcnt vmcnt(3)
  v_max3_u32 v247, v96, v97, v98
  v_max_u32 v247, v247, v99
  v_cmp_eq_u32 vcc, -1, v247
  s_cbranch_vccnz L_ob_86
L_obd_87:
  v_mfma_f32_32x32x16_bf16 v[128:143], v[208:211], v[96:99], v[128:143]
  v_mfma_f32_32x32x16_bf16 v[144:159], v[212:215], v[96:99], v[144:159]
  s_waitcnt vmcnt(2)
  v_max3_u32 v247, v100, v101, v102
  v_max_u32 v247, v247, v103
  v_cmp_eq_u32 vcc, -1, v247
  s_cbranch_vccnz L_ob_88
L_obd_89:
  v_mfma_f32_32x32x16_bf16 v[128:143], v[216:219], v[100:103], v[128:143]
  v_mfma_f32_32x32x16_bf16 v[144:159], v[220:223], v[100:103], v[144:159]
  s_waitcnt vmcnt(1)
  v_max3_u32 v247, v104, v105, v106
  v_max_u32 v247, v247, v107
  v_cmp_eq_u32 vcc, -1, v247
  s_cbranch_vccnz L_ob_90
L_obd_91:
  v_mfma_f32_32x32x16_bf16 v[128:143], v[224:227], v[104:107], v[128:143]
  v_mfma_f32_32x32x16_bf16 v[144:159], v[228:231], v[104:107], v[144:159]
  s_waitcnt vmcnt(0)
  v_max3_u32 v247, v108, v109, v110
  v_max_u32 v247, v247, v111
  v_cmp_eq_u32 vcc, -1, v247
  s_cbranch_vccnz L_ob_92
L_obd_93:
  v_mfma_f32_32x32x16_bf16 v[128:143], v[232:235], v[108:111], v[128:143]
  v_mfma_f32_32x32x16_bf16 v[144:159], v[236:239], v[108:111], v[144:159]
  s_bitcmp1_b32 s54, 0
  s_cbranch_scc1 L_kq_95
  s_nop 8
  ds_write_b128 v12, v[128:131] offset:0
  ds_write_b128 v12, v[132:135] offset:1024
  ds_write_b128 v12, v[136:139] offset:8192
  ds_write_b128 v12, v[140:143] offset:9216
  ds_write_b128 v12, v[152:155] offset:24576
  ds_write_b128 v12, v[156:159] offset:25600
  s_waitcnt lgkmcnt(0)
  s_barrier
  ds_read_b128 v[80:83], v126 offset:0
  ds_read_b128 v[84:87], v126 offset:1024
  ds_read_b128 v[88:91], v126 offset:2048
  ds_read_b128 v[92:95], v126 offset:3072
  ds_read_b128 v[96:99], v126 offset:6144
  ds_read_b128 v[100:103], v126 offset:7168
  s_waitcnt lgkmcnt(4)
  v_pk_add_f32 v[144:145], v[144:145], v[80:81]
  v_pk_add_f32 v[146:147], v[146:147], v[82:83]
  v_pk_add_f32 v[148:149], v[148:149], v[84:85]
  v_pk_add_f32 v[150:151], v[150:151], v[86:87]
  s_waitcnt lgkmcnt(2)
  v_pk_add_f32 v[144:145], v[144:145], v[88:89]
  v_pk_add_f32 v[146:147], v[146:147], v[90:91]
  v_pk_add_f32 v[148:149], v[148:149], v[92:93]
  v_pk_add_f32 v[150:151], v[150:151], v[94:95]
  s_waitcnt lgkmcnt(0)
  s_nop 0
  v_pk_add_f32 v[144:145], v[144:145], v[96:97]
  v_pk_add_f32 v[146:147], v[146:147], v[98:99]
  v_pk_add_f32 v[148:149], v[148:149], v[100:101]
  v_pk_add_f32 v[150:151], v[150:151], v[102:103]
  v_cvt_pk_bf16_f32 v80, v144, v145
  v_cvt_pk_bf16_f32 v81, v146, v147
  v_cvt_pk_bf16_f32 v82, v148, v149
  v_cvt_pk_bf16_f32 v83, v150, v151
  s_branch L_kqj_96
L_kq_95:
  s_nop 8
  ds_write_b128 v12, v[128:131] offset:0
  ds_write_b128 v12, v[132:135] offset:1024
  ds_write_b128 v12, v[136:139] offset:8192
  ds_write_b128 v12, v[140:143] offset:9216
  ds_write_b128 v12, v[144:147] offset:16384
  ds_write_b128 v12, v[148:151] offset:17408
  s_waitcnt lgkmcnt(0)
  s_barrier
  ds_read_b128 v[80:83], v126 offset:0
  ds_read_b128 v[84:87], v126 offset:1024
  ds_read_b128 v[88:91], v126 offset:2048
  ds_read_b128 v[92:95], v126 offset:3072
  ds_read_b128 v[96:99], v126 offset:4096
  ds_read_b128 v[100:103], v126 offset:5120
  s_waitcnt lgkmcnt(4)
  v_pk_add_f32 v[152:153], v[152:153], v[80:81]
  v_pk_add_f32 v[154:155], v[154:155], v[82:83]
  v_pk_add_f32 v[156:157], v[156:157], v[84:85]
  v_pk_add_f32 v[158:159], v[158:159], v[86:87]
  s_waitcnt lgkmcnt(2)
  v_pk_add_f32 v[152:153], v[152:153], v[88:89]
  v_pk_add_f32 v[154:155], v[154:155], v[90:91]
  v_pk_add_f32 v[156:157], v[156:157], v[92:93]
  v_pk_add_f32 v[158:159], v[158:159], v[94:95]
  s_waitcnt lgkmcnt(0)
  s_nop 0
  v_pk_add_f32 v[152:153], v[152:153], v[96:97]
  v_pk_add_f32 v[154:155], v[154:155], v[98:99]
  v_pk_add_f32 v[156:157], v[156:157], v[100:101]
  v_pk_add_f32 v[158:159], v[158:159], v[102:103]
  v_cvt_pk_bf16_f32 v80, v152, v153
  v_cvt_pk_bf16_f32 v81, v154, v155
  v_cvt_pk_bf16_f32 v82, v156, v157
  v_cvt_pk_bf16_f32 v83, v158, v159
L_kqj_96:
  buffer_store_dwordx4 v[80:83], v14, s[16:19], 0 offen sc1
L_idle_77:
  s_endpgm
L_fb_74:
  s_lshl_b32 s60, s47, 12
  v_subrev_u32 v12, s60, v12
  v_mov_b32 v11, 0xff7fffff
  s_mov_b32 s73, 0
  v_mov_b32 v160, 0
  v_mov_b32 v161, 0
  v_mov_b32 v162, 0
  v_mov_b32 v163, 0
  v_mov_b32 v164, 0
  v_mov_b32 v165, 0
  v_mov_b32 v166, 0
  v_mov_b32 v167, 0
  v_mov_b32 v168, 0
  v_mov_b32 v169, 0
  v_mov_b32 v170, 0
  v_mov_b32 v171, 0
  v_mov_b32 v172, 0
  v_mov_b32 v173, 0
  v_mov_b32 v174, 0
  v_mov_b32 v175, 0
L_fbl_76:
  buffer_load_dwordx4 v[136:139], v12, s[12:15], s73 offen sc1
  buffer_load_dwordx4 v[140:143], v12, s[12:15], s73 offen offset:1024 sc1
  buffer_load_dwordx4 v[144:147], v12, s[12:15], s73 offen offset:2048 sc1
  buffer_load_dwordx4 v[148:151], v12, s[12:15], s73 offen offset:3072 sc1
  s_waitcnt vmcnt(0)
  v_mfma_f32_32x32x16_bf16 v[192:207], v[136:139], v[128:131], 0
  v_mfma_f32_32x32x16_bf16 v[192:207], v[140:143], v[132:135], v[192:207]
  s_nop 11
  v_max3_f32 v247, v11, v192, v193
  v_max3_f32 v247, v247, v194, v195
  v_max3_f32 v247, v247, v196, v197
  v_max3_f32 v247, v247, v198, v199
  v_max3_f32 v247, v247, v200, v201
  v_max3_f32 v247, v247, v202, v203
  v_max3_f32 v247, v247, v204, v205
  v_max3_f32 v247, v247, v206, v207
  v_mov_b32 v248, v247
  s_nop 1
  v_permlane32_swap_b32 v247, v248
  v_max_f32 v247, v247, v248
  v_sub_f32 v248, v11, v247
  v_exp_f32 v248, v248
  v_mov_b32 v11, v247
  v_sub_f32 v192, v192, v247
  v_mul_f32 v160, v160, v248
  v_sub_f32 v193, v193, v247
  v_mul_f32 v161, v161, v248
  v_sub_f32 v194, v194, v247
  v_mul_f32 v162, v162, v248
  v_sub_f32 v195, v195, v247
  v_mul_f32 v163, v163, v248
  v_sub_f32 v196, v196, v247
  v_mul_f32 v164, v164, v248
  v_sub_f32 v197, v197, v247
  v_mul_f32 v165, v165, v248
  v_sub_f32 v198, v198, v247
  v_mul_f32 v166, v166, v248
  v_sub_f32 v199, v199, v247
  v_mul_f32 v167, v167, v248
  v_sub_f32 v200, v200, v247
  v_mul_f32 v168, v168, v248
  v_sub_f32 v201, v201, v247
  v_mul_f32 v169, v169, v248
  v_sub_f32 v202, v202, v247
  v_mul_f32 v170, v170, v248
  v_sub_f32 v203, v203, v247
  v_mul_f32 v171, v171, v248
  v_sub_f32 v204, v204, v247
  v_mul_f32 v172, v172, v248
  v_sub_f32 v205, v205, v247
  v_mul_f32 v173, v173, v248
  v_sub_f32 v206, v206, v247
  v_mul_f32 v174, v174, v248
  v_sub_f32 v207, v207, v247
  v_mul_f32 v175, v175, v248
  v_exp_f32 v192, v192
  v_exp_f32 v193, v193
  v_exp_f32 v194, v194
  v_exp_f32 v195, v195
  v_exp_f32 v196, v196
  v_exp_f32 v197, v197
  v_exp_f32 v198, v198
  v_exp_f32 v199, v199
  v_exp_f32 v200, v200
  v_exp_f32 v201, v201
  v_exp_f32 v202, v202
  v_exp_f32 v203, v203
  v_exp_f32 v204, v204
  v_exp_f32 v205, v205
  v_exp_f32 v206, v206
  v_exp_f32 v207, v207
  s_nop 1
  v_smfmac_f32_32x32x32_bf16 v[160:175], v[144:147], v[192:199], v10
  v_smfmac_f32_32x32x32_bf16 v[160:175], v[148:151], v[200:207], v10
  s_add_u32 s73, s73, 4096
  s_cmp_lt_u32 s73, 131072
  s_cbranch_scc1 L_fbl_76
  s_nop 8
  v_mov_b32 v152, v172
  v_mov_b32 v247, v172
  s_nop 1
  v_permlane32_swap_b32 v247, v152
  v_mov_b32 v153, v11
  ds_write_b128 v124, v[160:163]
  ds_write_b128 v124, v[164:167] offset:1024
  ds_write_b64 v5, v[152:153] offset:2048
  s_branch L_fbback_75
L_kp_53:
  s_mov_b32 s75, 262144
L_kp_53_a:
  buffer_load_dword v4, v5, s[12:15], 0 offen sc1
  s_waitcnt vmcnt(0)
  v_cmp_eq_u32 vcc, s51, v4
  s_nop 0
  s_lshr_b32 s76, vcc_lo, 16
  s_and_b32 s76, s76, vcc_lo
  s_lshr_b32 s58, s76, 8
  s_and_b32 s76, s76, s58
  s_and_b32 s76, s76, 0xff
  s_bitcmp1_b32 s76, 0
  s_cbranch_scc1 L_kpd_54
  s_sleep 2
  s_sub_u32 s75, s75, 1
  s_cbranch_scc0 L_kp_53_a
  s_branch L_kpd_54
L_kp_55:
  s_mov_b32 s75, 262144
L_kp_55_a:
  buffer_load_dword v4, v5, s[12:15], 0 offen sc1
  s_waitcnt vmcnt(0)
  v_cmp_eq_u32 vcc, s51, v4
  s_nop 0
  s_lshr_b32 s76, vcc_lo, 16
  s_and_b32 s76, s76, vcc_lo
  s_lshr_b32 s58, s76, 8
  s_and_b32 s76, s76, s58
  s_and_b32 s76, s76, 0xff
  s_bitcmp1_b32 s76, 1
  s_cbranch_scc1 L_kpd_56
  s_sleep 2
  s_sub_u32 s75, s75, 1
  s_cbranch_scc0 L_kp_55_a
  s_branch L_kpd_56
L_kp_57:
  s_mov_b32 s75, 262144
L_kp_57_a:
  buffer_load_dword v4, v5, s[12:15], 0 offen sc1
  s_waitcnt vmcnt(0)
  v_cmp_eq_u32 vcc, s51, v4
  s_nop 0
  s_lshr_b32 s76, vcc_lo, 16
  s_and_b32 s76, s76, vcc_lo
  s_lshr_b32 s58, s76, 8
  s_and_b32 s76, s76, s58
  s_and_b32 s76, s76, 0xff
  s_bitcmp1_b32 s76, 2
  s_cbranch_scc1 L_kpd_58
  s_sleep 2
  s_sub_u32 s75, s75, 1
  s_cbranch_scc0 L_kp_57_a
  s_branch L_kpd_58
L_kp_59:
  s_mov_b32 s75, 262144
L_kp_59_a:
  buffer_load_dword v4, v5, s[12:15], 0 offen sc1
  s_waitcnt vmcnt(0)
  v_cmp_eq_u32 vcc, s51, v4
  s_nop 0
  s_lshr_b32 s76, vcc_lo, 16
  s_and_b32 s76, s76, vcc_lo
  s_lshr_b32 s58, s76, 8
  s_and_b32 s76, s76, s58
  s_and_b32 s76, s76, 0xff
  s_bitcmp1_b32 s76, 3
  s_cbranch_scc1 L_kpd_60
  s_sleep 2
  s_sub_u32 s75, s75, 1
  s_cbranch_scc0 L_kp_59_a
  s_branch L_kpd_60
L_w_61:
  s_and_b32 s60, s2, 127
  s_mul_i32 s60, s60, 3136
  s_cmp_lt_u32 s2, 128
  s_cselect_b32 s16, s30, s34
  s_cselect_b32 s17, s31, s35
  s_mov_b32 s18, 401408
  s_mov_b32 s19, 0x20000
  v_min_u32 v252, 48, v1
  v_lshl_add_u32 v252, v252, 6, s60
  buffer_load_dword v152, v252, s[16:19], 0 offen
  s_branch L_w_61_b
L_kp_62:
  s_mov_b32 s75, 262144
L_kp_62_a:
  buffer_load_dword v4, v5, s[12:15], 0 offen sc1
  s_waitcnt vmcnt(0)
  v_cmp_eq_u32 vcc, s51, v4
  s_nop 0
  s_lshr_b32 s76, vcc_lo, 16
  s_and_b32 s76, s76, vcc_lo
  s_lshr_b32 s58, s76, 8
  s_and_b32 s76, s76, s58
  s_and_b32 s76, s76, 0xff
  s_bitcmp1_b32 s76, 4
  s_cbranch_scc1 L_kpd_63
  s_sleep 2
  s_sub_u32 s75, s75, 1
  s_cbranch_scc0 L_kp_62_a
  s_branch L_kpd_63
L_kp_64:
  s_mov_b32 s75, 262144
L_kp_64_a:
  buffer_load_dword v4, v5, s[12:15], 0 offen sc1
  s_waitcnt vmcnt(0)
  v_cmp_eq_u32 vcc, s51, v4
  s_nop 0
  s_lshr_b32 s76, vcc_lo, 16
  s_and_b32 s76, s76, vcc_lo
  s_lshr_b32 s58, s76, 8
  s_and_b32 s76, s76, s58
  s_and_b32 s76, s76, 0xff
  s_bitcmp1_b32 s76, 5
  s_cbranch_scc1 L_kpd_65
  s_sleep 2
  s_sub_u32 s75, s75, 1
  s_cbranch_scc0 L_kp_64_a
  s_branch L_kpd_65
L_poll_66:
  s_mov_b32 s75, 262144
L_poll_66_a:
  s_sleep 4
  buffer_load_dword v124, v14, s[12:15], 0 offen sc1
  s_waitcnt vmcnt(0)
  v_cmp_ne_u32 vcc, s51, v124
  s_cbranch_vccz L_polled_67
  s_sub_u32 s75, s75, 1
  s_cbranch_scc0 L_poll_66_a
  s_branch L_polled_67
L_kp_68:
  s_mov_b32 s75, 262144
L_kp_68_a:
  buffer_load_dword v4, v5, s[12:15], 0 offen sc1
  s_waitcnt vmcnt(0)
  v_cmp_eq_u32 vcc, s51, v4
  s_nop 0
  s_lshr_b32 s76, vcc_lo, 16
  s_and_b32 s76, s76, vcc_lo
  s_lshr_b32 s58, s76, 8
  s_and_b32 s76, s76, s58
  s_and_b32 s76, s76, 0xff
  s_bitcmp1_b32 s76, 6
  s_cbranch_scc1 L_kpd_69
  s_sleep 2
  s_sub_u32 s75, s75, 1
  s_cbranch_scc0 L_kp_68_a
  s_branch L_kpd_69
L_kp_70:
  s_mov_b32 s75, 262144
L_kp_70_a:
  buffer_load_dword v4, v5, s[12:15], 0 offen sc1
  s_waitcnt vmcnt(0)
  v_cmp_eq_u32 vcc, s51, v4
  s_nop 0
  s_lshr_b32 s76, vcc_lo, 16
  s_and_b32 s76, s76, vcc_lo
  s_lshr_b32 s58, s76, 8
  s_and_b32 s76, s76, s58
  s_and_b32 s76, s76, 0xff
  s_bitcmp1_b32 s76, 7
  s_cbranch_scc1 L_kpd_71
  s_sleep 2
  s_sub_u32 s75, s75, 1
  s_cbranch_scc0 L_kp_70_a
  s_branch L_kpd_71
L_poll_72:
  s_mov_b32 s75, 262144
L_poll_72_a:
  s_sleep 4
  buffer_load_dword v244, v245, s[12:15], 0 offen sc1
  s_waitcnt vmcnt(0)
  v_cmp_ne_u32 vcc, s51, v244
  s_cbranch_vccz L_polled_73
  s_sub_u32 s75, s75, 1
  s_cbranch_scc0 L_poll_72_a
  s_branch L_polled_73
L_ob_78:
  s_sleep 6
  buffer_load_dwordx4 v[80:83], v9, s[12:15], 0 offen offset:0 sc1
  buffer_load_dwordx4 v[84:87], v9, s[12:15], 0 offen offset:1024 sc1
  buffer_load_dwordx4 v[88:91], v9, s[12:15], 0 offen offset:2048 sc1
  buffer_load_dwordx4 v[92:95], v9, s[12:15], 0 offen offset:3072 sc1
  buffer_load_dwordx4 v[96:99], v9, s[12:15], s52 offen offset:0 sc1
  buffer_load_dwordx4 v[100:103], v9, s[12:15], s52 offen offset:1024 sc1
  buffer_load_dwordx4 v[104:107], v9, s[12:15], s52 offen offset:2048 sc1
  buffer_load_dwordx4 v[108:111], v9, s[12:15], s52 offen offset:3072 sc1
  s_waitcnt vmcnt(7)
  v_max3_u32 v247, v80, v81, v82
  v_max_u32 v247, v247, v83
  v_cmp_eq_u32 vcc, -1, v247
  s_sub_u32 s75, s75, 1
  s_cbranch_scc1 L_obd_79
  s_cbranch_vccnz L_ob_78
  s_branch L_obd_79
L_ob_80:
  s_sleep 6
  buffer_load_dwordx4 v[84:87], v9, s[12:15], 0 offen offset:1024 sc1
  buffer_load_dwordx4 v[88:91], v9, s[12:15], 0 offen offset:2048 sc1
  buffer_load_dwordx4 v[92:95], v9, s[12:15], 0 offen offset:3072 sc1
  buffer_load_dwordx4 v[96:99], v9, s[12:15], s52 offen offset:0 sc1
  buffer_load_dwordx4 v[100:103], v9, s[12:15], s52 offen offset:1024 sc1
  buffer_load_dwordx4 v[104:107], v9, s[12:15], s52 offen offset:2048 sc1
  buffer_load_dwordx4 v[108:111], v9, s[12:15], s52 offen offset:3072 sc1
  s_waitcnt vmcnt(6)
  v_max3_u32 v247, v84, v85, v86
  v_max_u32 v247, v247, v87
  v_cmp_eq_u32 vcc, -1, v247
  s_sub_u32 s75, s75, 1
  s_cbranch_scc1 L_obd_81
  s_cbranch_vccnz L_ob_80
  s_branch L_obd_81
L_ob_82:
  s_sleep 6
  buffer_load_dwordx4 v[88:91], v9, s[12:15], 0 offen offset:2048 sc1
  buffer_load_dwordx4 v[92:95], v9, s[12:15], 0 offen offset:3072 sc1
  buffer_load_dwordx4 v[96:99], v9, s[12:15], s52 offen offset:0 sc1
  buffer_load_dwordx4 v[100:103], v9, s[12:15], s52 offen offset:1024 sc1
  buffer_load_dwordx4 v[104:107], v9, s[12:15], s52 offen offset:2048 sc1
  buffer_load_dwordx4 v[108:111], v9, s[12:15], s52 offen offset:3072 sc1
  s_waitcnt vmcnt(5)
  v_max3_u32 v247, v88, v89, v90
  v_max_u32 v247, v247, v91
  v_cmp_eq_u32 vcc, -1, v247
  s_sub_u32 s75, s75, 1
  s_cbranch_scc1 L_obd_83
  s_cbranch_vccnz L_ob_82
  s_branch L_obd_83
L_ob_84:
  s_sleep 6
  buffer_load_dwordx4 v[92:95], v9, s[12:15], 0 offen offset:3072 sc1
  buffer_load_dwordx4 v[96:99], v9, s[12:15], s52 offen offset:0 sc1
  buffer_load_dwordx4 v[100:103], v9, s[12:15], s52 offen offset:1024 sc1
  buffer_load_dwordx4 v[104:107], v9, s[12:15], s52 offen offset:2048 sc1
  buffer_load_dwordx4 v[108:111], v9, s[12:15], s52 offen offset:3072 sc1
  s_waitcnt vmcnt(4)
  v_max3_u32 v247, v92, v93, v94
  v_max_u32 v247, v247, v95
  v_cmp_eq_u32 vcc, -1, v247
  s_sub_u32 s75, s75, 1
  s_cbranch_scc1 L_obd_85
  s_cbranch_vccnz L_ob_84
  s_branch L_obd_85
L_ob_86:
  s_sleep 6
  buffer_load_dwordx4 v[96:99], v9, s[12:15], s52 offen offset:0 sc1
  buffer_load_dwordx4 v[100:103], v9, s[12:15], s52 offen offset:1024 sc1
  buffer_load_dwordx4 v[104:107], v9, s[12:15], s52 offen offset:2048 sc1
  buffer_load_dwordx4 v[108:111], v9, s[12:15], s52 offen offset:3072 sc1
  s_waitcnt vmcnt(3)
  v_max3_u32 v247, v96, v97, v98
  v_max_u32 v247, v247, v99
  v_cmp_eq_u32 vcc, -1, v247
  s_sub_u32 s75, s75, 1
  s_cbranch_scc1 L_obd_87
  s_cbranch_vccnz L_ob_86
  s_branch L_obd_87
L_ob_88:
  s_sleep 6
  buffer_load_dwordx4 v[100:103], v9, s[12:15], s52 offen offset:1024 sc1
  buffer_load_dwordx4 v[104:107], v9, s[12:15], s52 offen offset:2048 sc1
  buffer_load_dwordx4 v[108:111], v9, s[12:15], s52 offen offset:3072 sc1
  s_waitcnt vmcnt(2)
  v_max3_u32 v247, v100, v101, v102
  v_max_u32 v247, v247, v103
  v_cmp_eq_u32 vcc, -1, v247
  s_sub_u32 s75, s75, 1
  s_cbranch_scc1 L_obd_89
  s_cbranch_vccnz L_ob_88
  s_branch L_obd_89
L_ob_90:
  s_sleep 6
  buffer_load_dwordx4 v[104:107], v9, s[12:15], s52 offen offset:2048 sc1
  buffer_load_dwordx4 v[108:111], v9, s[12:15], s52 offen offset:3072 sc1
  s_waitcnt vmcnt(1)
  v_max3_u32 v247, v104, v105, v106
  v_max_u32 v247, v247, v107
  v_cmp_eq_u32 vcc, -1, v247
  s_sub_u32 s75, s75, 1
  s_cbranch_scc1 L_obd_91
  s_cbranch_vccnz L_ob_90
  s_branch L_obd_91
L_ob_92:
  s_sleep 6
  buffer_load_dwordx4 v[108:111], v9, s[12:15], s52 offen offset:3072 sc1
  s_waitcnt vmcnt(0)
  v_max3_u32 v247, v108, v109, v110
  v_max_u32 v247, v247, v111
  v_cmp_eq_u32 vcc, -1, v247
  s_sub_u32 s75, s75, 1
  s_cbranch_scc1 L_obd_93
  s_cbranch_vccnz L_ob_92
  s_branch L_obd_93
L_end:
  s_endpgm
.section .rodata,"a"
.p2align 6
.amdhsa_kernel gated_mix__linear_kernel_hedgehog__softmax_full_mha__prompt_kernel
  .amdhsa_next_free_vgpr 256
  .amdhsa_next_free_sgpr 102
  .amdhsa_accum_offset 256
  .amdhsa_group_segment_fixed_size 0
  .amdhsa_kernarg_size 88
  .amdhsa_user_sgpr_count 2
  .amdhsa_user_sgpr_kernarg_segment_ptr 1
  .amdhsa_system_sgpr_workgroup_id_x 1
.end_amdhsa_kernel
```
